```python
import torch

def _softmax(x, axis=-1):
    return torch.softmax(x, dim=axis)
def _gelu(x):
    return torch.nn.functional.gelu(x, approximate="tanh")
def _silu(x):
    return torch.nn.functional.silu(x)
def _sigmoid(x):
    return torch.sigmoid(x)
def _layernorm(x, axis=-1, eps=1e-5):
    m = x.mean(dim=axis, keepdim=True)
    v = x.var(dim=axis, keepdim=True, unbiased=False)
    return (x - m) / torch.sqrt(v + eps)
def _scatter_add(tgt, idx, src, axis=0):
    return tgt.clone().index_add_(axis, idx, src)
def _segment_sum(src, seg, n):
    out = torch.zeros((n,) + src.shape[1:], dtype=src.dtype)
    return out.index_add_(0, seg, src)
def _pad(x, pw):
    flat = tuple(v for pair in reversed(pw) for v in pair)
    return torch.nn.functional.pad(x, flat)

kernel_name = 'recurrent_scan__compressed_kv_cla__mixer_channel_mlp__decode'

def setup_inputs():

    _w = (lambda a: (lambda t: t.to(torch.bfloat16) if t.is_floating_point() else t)(torch.as_tensor(a)))
    def _A_setup():
        B, H, Sq, Sk, D, M = 1, 32, 1, 8192, 128, 512
        Dc = 4 * D
        return {
            "x": _w((lambda *s: torch.randn(*s, dtype=torch.bfloat16) * 0.1)(B, Sq, M)),
            "c_kv": _w((lambda *s: torch.randn(*s, dtype=torch.bfloat16) * 3.2)(B, Sk, Dc)),
            "w_q": _w((lambda *s: torch.randn(*s, dtype=torch.bfloat16) * 0.8)(M, H, D) * (M ** -0.5)),
            "w_uk": _w((lambda *s: torch.randn(*s, dtype=torch.bfloat16) * 0.8)(Dc, H, D) * (Dc ** -0.5)),
            "w_uv": _w((lambda *s: torch.randn(*s, dtype=torch.bfloat16) * 3.2)(Dc, H, D) * (Dc ** -0.5)),
            "w_o": _w((lambda *s: torch.randn(*s, dtype=torch.bfloat16) * 3.2)(H, D, M) * ((H * D) ** -0.5)),
        }
    _A_in = _A_setup()

    def _B_setup():
        B, S, D, F = 1, 1, 512, 1376
        return {
            "x": _w((lambda *s: torch.randn(*s, dtype=torch.bfloat16) * 0.1)(B, S, D)),
            "w1": _w((lambda *s: torch.randn(*s, dtype=torch.bfloat16) * 3.2)(D, F) * (D ** -0.5)),
            "b1": _w((lambda *s: torch.randn(*s, dtype=torch.bfloat16) * 3.2)(F)),
            "w2": _w((lambda *s: torch.randn(*s, dtype=torch.bfloat16) * 3.2)(F, D) * (F ** -0.5)),
            "b2": _w((lambda *s: torch.randn(*s, dtype=torch.bfloat16) * 3.2)(D)),
        }
    _B_in = _B_setup()

    return {
        "A_x": _A_in["x"],
        "A_c_kv": _A_in["c_kv"],
        "A_w_q": _A_in["w_q"],
        "A_w_uk": _A_in["w_uk"],
        "A_w_uv": _A_in["w_uv"],
        "A_w_o": _A_in["w_o"],
        "B_x": _B_in["x"],
        "B_w1": _B_in["w1"],
        "B_b1": _B_in["b1"],
        "B_w2": _B_in["w2"],
        "B_b2": _B_in["b2"],
    }

def reference(A_x, A_c_kv, A_w_q, A_w_uk, A_w_uv, A_w_o, B_x, B_w1, B_b1, B_w2, B_b2):
    def _A_ref(x, c_kv, w_q, w_uk, w_uv, w_o):
        B, Sq, M = x.shape[0], x.shape[1], x.shape[2]
        Sk = c_kv.shape[1]
        H, D = w_q.shape[1], w_q.shape[2]
        q = torch.einsum("bqm,mhd->bhqd", x, w_q)
        k = torch.einsum("bkc,chd->bhkd", c_kv, w_uk)
        v = torch.einsum("bkc,chd->bhkd", c_kv, w_uv)
        scores = torch.einsum("bhqd,bhkd->bhqk", q, k) * (D ** -0.5)
        off = Sk - Sq
        qi = torch.arange(Sq)[:, None]
        kj = torch.arange(Sk)[None, :]
        cmask = kj <= (qi + off)
        scores = torch.where(cmask[None, None], scores, -1e9)
        p = _softmax(scores, axis=-1)
        ctx = torch.einsum("bhqk,bhkd->bhqd", p, v)
        return torch.einsum("bhqd,hdm->bqm", ctx, w_o)

    def _B_ref(x, w1, b1, w2, b2):
        y = _layernorm(x, axis=-1)
        h = _gelu(torch.einsum("bsd,df->bsf", y, w1) + b1)
        return torch.einsum("bsf,fd->bsd", h, w2) + b2

    x = A_x
    xn = _layernorm(x, axis=-1)
    s = _A_ref(xn, A_c_kv, A_w_q, A_w_uk, A_w_uv, A_w_o)
    g = _silu(_B_ref(xn, B_w1, B_b1, B_w2, B_b2))
    return x + s * g
```

```asm
; @launch grid=(256,1,1) block=(512,1,1) lds=163840
.amdgcn_target "amdgcn-amd-amdhsa--gfx950"
.text
.globl recurrent_scan__compressed_kv_cla__mixer_channel_mlp__decode_kernel
.p2align 8
.type recurrent_scan__compressed_kv_cla__mixer_channel_mlp__decode_kernel,@function
recurrent_scan__compressed_kv_cla__mixer_channel_mlp__decode_kernel:
    s_load_dwordx8 s[8:15], s[0:1], 0
    s_cmpk_ge_u32 s2, 256
    s_cbranch_scc1 L_exit0
    s_load_dwordx2 s[36:37], s[0:1], 104
    s_load_dwordx16 s[16:31], s[0:1], 32
    v_readfirstlane_b32 s3, v0
    v_and_b32 v0, 63, v0
    s_and_b32 s5, s2, 7
    s_lshr_b32 s6, s2, 3
    v_and_b32 v1, 15, v0
    v_lshrrev_b32 v2, 4, v0
    v_lshlrev_b32 v10, 4, v0
    s_lshr_b32 s3, s3, 6
    s_and_b32 s4, s3, 3
    s_cmp_ge_u32 s3, 4
    s_cbranch_scc1 L_pf
    s_lshl_b32 s58, s5, 2
    s_mul_i32 s59, s4, 8704
    s_bitset1_b32 s59, 16
    s_bitcmp1_b32 s2, 7
    s_cbranch_scc1 L_pb
    s_lshr_b32 s60, s6, 2
    s_add_u32 s58, s58, s60
    s_and_b32 s60, s6, 3
    s_lshl_b32 s60, s60, 5
    s_add_u32 s60, s60, s4
    s_lshl_b32 s61, 16, 13
    v_lshlrev_b32 v11, 2, v2
    s_branch L_pj
L_exit0:
    s_endpgm
L_pb:
    s_add_u32 s58, s58, s4
    s_and_b32 s60, s6, 15
    s_lshl_b32 s60, s60, 3
    s_lshl_b32 s61, 4, 13
    v_mov_b32 v11, v2
L_pj:
    s_lshl_b32 s60, s60, 7
    s_add_u32 s58, s58, s60
    s_lshl_b32 s58, s58, 8
    v_xor_b32 v11, v11, v1
    v_lshlrev_b32 v11, 4, v11
    v_lshlrev_b32 v12, 13, v2
    v_add3_u32 v12, v12, v11, s58
    s_movk_i32 s60, 0x80
    s_bitcmp1_b32 s2, 7
    s_waitcnt lgkmcnt(0)
    global_load_dwordx4 v[24:27], v10, s[8:9]
    s_cselect_b64 s[12:13], s[14:15], s[12:13]
    s_cbranch_scc1 L_yl
L_wl:
    s_mov_b32 m0, s59
    s_addk_i32 s59, 1088
    global_load_lds_dwordx4 v12, s[12:13]
    v_add_u32 v12, s61, v12
    s_lshr_b32 s60, s60, 1
    s_cbranch_scc1 L_wl
    s_branch L_common
L_yl:
    s_mov_b32 m0, s59
    s_addk_i32 s59, 1088
    global_load_lds_dwordx4 v12, s[12:13]
    v_add_u32 v12, s61, v12
    s_movk_i32 s60, 0x40
    s_waitcnt vmcnt(1)
    s_branch L_wl
L_pf:
    s_bitcmp0_b32 s2, 7
    s_cbranch_scc1 L_common
    s_getpc_b64 s[62:63]
L_pc:
    s_and_b32 s58, s6, 15
    s_lshl2_add_u32 s58, s58, s4
    s_lshl_b32 s58, s58, 8
    v_lshl_add_u32 v12, v0, 2, s58
    v_min_u32 v12, L_codeend-L_pc-4, v12
    global_load_dword v11, v12, s[62:63]
L_common:
    s_mov_b32 s38, 0x10000000
    s_mov_b32 s39, 0x20000
    v_mov_b32 v3, 157696
    v_mov_b32 v6, 0
    v_lshl_add_u32 v5, v0, 2, v3
    ds_write_b32 v5, v6
    s_mov_b32 s7, 0x400000
    s_mov_b32 s57, 0xffffff00
    s_lshr_b32 s35, s3, 2
    s_lshl_b32 s34, s5, 14
    s_add_u32 s34, s34, 73728
    s_and_b32 s58, s6, 15
    s_lshl4_add_u32 s58, s35, s58
    s_lshl2_add_u32 s58, s58, s4
    s_lshl2_add_u32 s32, s58, s34
    v_lshl_add_u32 v4, s3, 2, v3
    v_lshl_add_u32 v7, s35, 4, v3
    v_or_b32 v8, 16, v4
    v_mov_b32 v5, 1
    s_waitcnt lgkmcnt(0)
    s_cmp_lt_u32 s3, 4
    s_cbranch_scc1 L_g0
    s_bitcmp0_b32 s2, 7
    s_cbranch_scc1 L_nt
    s_and_b32 s58, s6, 3
    s_lshl2_add_u32 s58, s58, s4
    s_lshl_b32 s58, s58, 10
    s_add_u32 s58, s58, s34
    s_sub_u32 s58, s58, 8192
    buffer_load_dwordx4 v[24:27], v10, s[36:39], s58 offen sc1
    s_barrier
    s_branch L_y
L_nt:
    s_barrier
    s_branch L_x
L_g0:
    buffer_load_dword v20, v6, s[36:39], 0 offen sc1
    s_barrier
    s_waitcnt vmcnt(9)
    v_lshlrev_b32 v28, 16, v24
    v_and_b32 v29, 0xffff0000, v24
    v_lshlrev_b32 v30, 16, v25
    v_and_b32 v31, 0xffff0000, v25
    v_lshlrev_b32 v32, 16, v26
    v_and_b32 v33, 0xffff0000, v26
    v_lshlrev_b32 v34, 16, v27
    v_and_b32 v35, 0xffff0000, v27
    v_add_f32 v36, v28, v29
    v_add_f32 v37, v30, v31
    v_add_f32 v36, v36, v32
    v_add_f32 v37, v37, v33
    v_add_f32 v36, v36, v34
    v_add_f32 v37, v37, v35
    v_add_f32 v36, v36, v37
    s_nop 1
    v_add_f32_dpp v36, v36, v36 row_ror:8 row_mask:0xf bank_mask:0xf
    s_nop 1
    v_add_f32_dpp v36, v36, v36 row_ror:4 row_mask:0xf bank_mask:0xf
    s_nop 1
    v_add_f32_dpp v36, v36, v36 row_ror:2 row_mask:0xf bank_mask:0xf
    s_nop 1
    v_add_f32_dpp v36, v36, v36 row_ror:1 row_mask:0xf bank_mask:0xf
    v_mov_b32 v37, v36
    s_nop 1
    v_permlane16_swap_b32 v37, v36
    v_add_f32 v36, v36, v37
    v_mov_b32 v37, v36
    s_nop 1
    v_permlane32_swap_b32 v37, v36
    v_add_f32 v36, v36, v37
    v_mul_f32 v36, 0x3b000000, v36
    v_sub_f32 v37, v28, v36
    v_mul_f32 v38, v37, v37
    v_sub_f32 v37, v29, v36
    v_fmac_f32 v38, v37, v37
    v_sub_f32 v37, v30, v36
    v_fmac_f32 v38, v37, v37
    v_sub_f32 v37, v31, v36
    v_fmac_f32 v38, v37, v37
    v_sub_f32 v37, v32, v36
    v_fmac_f32 v38, v37, v37
    v_sub_f32 v37, v33, v36
    v_fmac_f32 v38, v37, v37
    v_sub_f32 v37, v34, v36
    v_fmac_f32 v38, v37, v37
    v_sub_f32 v37, v35, v36
    v_fmac_f32 v38, v37, v37
    s_nop 1
    v_add_f32_dpp v38, v38, v38 row_ror:8 row_mask:0xf bank_mask:0xf
    s_nop 1
    v_add_f32_dpp v38, v38, v38 row_ror:4 row_mask:0xf bank_mask:0xf
    s_nop 1
    v_add_f32_dpp v38, v38, v38 row_ror:2 row_mask:0xf bank_mask:0xf
    s_nop 1
    v_add_f32_dpp v38, v38, v38 row_ror:1 row_mask:0xf bank_mask:0xf
    v_mov_b32 v37, v38
    s_nop 1
    v_permlane16_swap_b32 v37, v38
    v_add_f32 v38, v38, v37
    v_mov_b32 v37, v38
    s_nop 1
    v_permlane32_swap_b32 v37, v38
    v_add_f32 v38, v38, v37
    v_mul_f32 v38, 0x3b000000, v38
    v_cvt_pk_bf16_f32 v36, v36, v36
    v_lshlrev_b32 v36, 16, v36
    v_cvt_pk_bf16_f32 v38, v38, v38
    v_lshlrev_b32 v38, 16, v38
    v_add_f32 v38, 0x3727c5ac, v38
    v_cvt_pk_bf16_f32 v38, v38, v38
    v_lshlrev_b32 v38, 16, v38
    v_sqrt_f32 v38, v38
    v_sub_f32 v28, v28, v36
    v_sub_f32 v29, v29, v36
    v_sub_f32 v30, v30, v36
    v_sub_f32 v31, v31, v36
    v_sub_f32 v32, v32, v36
    v_sub_f32 v33, v33, v36
    v_sub_f32 v34, v34, v36
    v_sub_f32 v35, v35, v36
    v_cvt_pk_bf16_f32 v38, v38, v38
    v_lshlrev_b32 v38, 16, v38
    v_rcp_f32 v38, v38
    v_cvt_pk_bf16_f32 v24, v28, v29
    v_cvt_pk_bf16_f32 v25, v30, v31
    v_cvt_pk_bf16_f32 v26, v32, v33
    v_cvt_pk_bf16_f32 v27, v34, v35
    v_lshlrev_b32 v28, 16, v24
    v_and_b32 v29, 0xffff0000, v24
    v_lshlrev_b32 v30, 16, v25
    v_and_b32 v31, 0xffff0000, v25
    v_lshlrev_b32 v32, 16, v26
    v_and_b32 v33, 0xffff0000, v26
    v_lshlrev_b32 v34, 16, v27
    v_and_b32 v35, 0xffff0000, v27
    v_mul_f32 v28, v28, v38
    v_mul_f32 v29, v29, v38
    v_mul_f32 v30, v30, v38
    v_mul_f32 v31, v31, v38
    v_mul_f32 v32, v32, v38
    v_mul_f32 v33, v33, v38
    v_mul_f32 v34, v34, v38
    v_mul_f32 v35, v35, v38
    v_cvt_pk_bf16_f32 v24, v28, v29
    v_cvt_pk_bf16_f32 v25, v30, v31
    v_cvt_pk_bf16_f32 v26, v32, v33
    v_cvt_pk_bf16_f32 v27, v34, v35
    s_bitcmp1_b32 s2, 7
    s_cbranch_scc1 L_b1
    v_add_u32 v39, 158208, v10
    ds_write_b128 v39, v[24:27]
    s_and_b32 s58, s6, 3
    s_lshl_b32 s58, s58, 8
    s_add_u32 s58, s58, 158208
    v_lshl_add_u32 v39, v2, 3, s58
    ds_read2_b64 v[44:47], v39 offset0:0 offset1:4
    ds_read2_b64 v[48:51], v39 offset0:8 offset1:12
    ds_read2_b64 v[52:55], v39 offset0:16 offset1:20
    ds_read2_b64 v[56:59], v39 offset0:24 offset1:28
    v_lshrrev_b32 v42, 2, v1
    v_xor_b32 v40, s4, v42
    v_lshlrev_b32 v40, 6, v40
    v_lshl_add_u32 v40, v42, 8, v40
    v_and_b32 v42, 3, v1
    v_lshl_add_u32 v40, v42, 4, v40
    v_mul_u32_u24 v42, 8704, v2
    v_add_u32 v40, v40, v42
    v_add_u32 v40, 65536, v40
    v_lshlrev_b32 v41, 4, v1
    v_lshl_add_u32 v41, v2, 5, v41
    s_lshl2_add_u32 s61, s6, s4
    s_lshl_b32 s61, s61, 7
    s_add_u32 s61, s61, s34
    s_sub_u32 s61, s61, 8192
    s_mov_b32 vcc_lo, 0xaaaaaaaa
    s_mov_b32 vcc_hi, 0xaaaaaaaa
    s_waitcnt vmcnt(3)
    s_barrier
    ds_read_b64_tr_b16 v[60:61], v40 offset:0
    ds_read_b64_tr_b16 v[62:63], v40 offset:1088
    ds_read_b64_tr_b16 v[64:65], v40 offset:8
    ds_read_b64_tr_b16 v[66:67], v40 offset:1096
    ds_read_b64_tr_b16 v[68:69], v40 offset:2176
    ds_read_b64_tr_b16 v[70:71], v40 offset:3264
    ds_read_b64_tr_b16 v[72:73], v40 offset:2184
    ds_read_b64_tr_b16 v[74:75], v40 offset:3272
    ds_read_b64_tr_b16 v[76:77], v40 offset:4352
    ds_read_b64_tr_b16 v[78:79], v40 offset:5440
    ds_read_b64_tr_b16 v[80:81], v40 offset:4360
    ds_read_b64_tr_b16 v[82:83], v40 offset:5448
    s_waitcnt lgkmcnt(0)
    v_mfma_f32_16x16x32_bf16 v[100:103], v[60:63], v[44:47], 0
    v_mfma_f32_16x16x32_bf16 v[104:107], v[64:67], v[44:47], 0
    v_mfma_f32_16x16x32_bf16 v[100:103], v[68:71], v[48:51], v[100:103]
    v_mfma_f32_16x16x32_bf16 v[104:107], v[72:75], v[48:51], v[104:107]
    v_mfma_f32_16x16x32_bf16 v[100:103], v[76:79], v[52:55], v[100:103]
    v_mfma_f32_16x16x32_bf16 v[104:107], v[80:83], v[52:55], v[104:107]
    s_waitcnt vmcnt(1)
    s_barrier
    ds_read_b64_tr_b16 v[84:85], v40 offset:6528
    ds_read_b64_tr_b16 v[86:87], v40 offset:7616
    ds_read_b64_tr_b16 v[88:89], v40 offset:6536
    ds_read_b64_tr_b16 v[90:91], v40 offset:7624
    s_waitcnt vmcnt(0)
    ds_write_b32 v3, v20 offset:224
    v_add_u32 v9, 0x9e3779b1, v20
    v_bfe_u32 v20, v9, 0, 8
    v_bfe_u32 v21, v9, 8, 8
    v_bfe_u32 v22, v9, 16, 8
    v_bfe_u32 v23, v9, 24, 8
    v_readfirstlane_b32 s56, v9
    s_waitcnt lgkmcnt(1)
    v_mfma_f32_16x16x32_bf16 v[100:103], v[84:87], v[56:59], v[100:103]
    v_mfma_f32_16x16x32_bf16 v[104:107], v[88:91], v[56:59], v[104:107]
    s_mov_b32 exec_lo, 0x30003
    s_mov_b32 exec_hi, 0x30003
    s_nop 5
    v_cndmask_b32 v116, v100, v104, vcc
    v_cndmask_b32 v117, v101, v105, vcc
    v_cndmask_b32 v118, v102, v106, vcc
    v_cndmask_b32 v119, v103, v107, vcc
    v_and_or_b32 v116, v116, s57, v20
    v_and_or_b32 v117, v117, s57, v21
    v_and_or_b32 v118, v118, s57, v22
    v_and_or_b32 v119, v119, s57, v23
    buffer_store_dwordx4 v[116:119], v41, s[36:39], s61 offen
    s_waitcnt lgkmcnt(0)
    s_barrier
    s_xor_b32 s61, s61, 8388608
    buffer_store_dwordx4 v[116:119], v41, s[36:39], s61 offen sc1
    s_mov_b64 exec, -1
    s_branch L_x
L_b1:
    v_lshrrev_b32 v39, 1, v1
    v_lshlrev_b32 v43, 8, v39
    v_lshl_add_u32 v43, v2, 5, v43
    v_and_b32 v39, 1, v1
    v_lshl_add_u32 v43, v39, 4, v43
    s_lshl_b32 s60, s4, 11
    s_add_u32 s60, s60, s34
    s_sub_u32 s60, s60, 8192
    s_mul_i32 s58, s4, 8704
    s_add_u32 s58, s58, 65536
    v_and_b32 v40, 3, v1
    v_xor_b32 v39, v40, v2
    v_lshlrev_b32 v39, 4, v39
    v_lshl_add_u32 v39, v40, 8, v39
    v_lshrrev_b32 v40, 2, v1
    v_mul_u32_u24 v40, 1088, v40
    v_add3_u32 v39, v39, v40, s58
    v_lshrrev_b32 v40, 3, v1
    v_lshl_add_u32 v40, v40, 2, 32
    v_and_b32 v42, 1, v1
    v_lshl_add_u32 v40, v42, 1, v40
    v_lshlrev_b32 v41, 1, v1
    v_and_b32 v42, 6, v1
    v_cmp_eq_u32 vcc, 6, v42
    s_nop 1
    v_cndmask_b32 v41, v41, v40, vcc
    s_mul_i32 s58, s4, 96
    s_add_u32 s58, s58, 160256
    v_lshrrev_b32 v37, 5, v0
    v_mul_u32_u24 v42, 48, v37
    v_add3_u32 v41, v41, v42, s58
    v_and_b32 v40, 3, v0
    v_bfe_u32 v36, v0, 2, 3
    v_mul_u32_u24 v42, 96, v40
    v_lshl_add_u32 v42, v36, 4, v42
    v_add_u32 v42, 160256, v42
    v_lshlrev_b32 v40, 4, v40
    v_lshl_add_u32 v40, v36, 10, v40
    s_and_b32 s58, s5, 4
    s_bfe_u32 s59, s6, 0x20002
    s_add_u32 s58, s58, s59
    s_mul_i32 s61, s58, 6144
    s_and_b32 s58, s6, 3
    s_and_b32 s59, s5, 3
    s_lshl2_add_u32 s58, s58, s59
    s_lshl_b32 s58, s58, 6
    s_add_u32 s61, s61, s58
    s_lshl_b32 s58, s4, 16
    s_add_u32 s61, s61, s58
    s_add_u32 s61, s61, 524288
    s_waitcnt vmcnt(0)
    buffer_load_dwordx4 v[92:95], v43, s[36:39], s60 offen offset:0 sc1
    buffer_load_dwordx4 v[96:99], v43, s[36:39], s60 offen offset:128 sc1
    s_mov_b32 s33, 0
    ds_read_b128 v[60:63], v39 offset:0
    ds_read_b128 v[64:67], v39 offset:64
    ds_read_b128 v[68:71], v39 offset:128
    ds_read_b128 v[72:75], v39 offset:192
    ds_read_b128 v[76:79], v39 offset:4352
    ds_read_b128 v[80:83], v39 offset:4416
    ds_read_b128 v[84:87], v39 offset:4480
    ds_read_b128 v[88:91], v39 offset:4544
    ds_write_b32 v3, v20 offset:224
    v_add_u32 v9, 0x9e3779b1, v20
    v_bfe_u32 v20, v9, 0, 8
    v_bfe_u32 v21, v9, 8, 8
    v_bfe_u32 v22, v9, 16, 8
    v_bfe_u32 v23, v9, 24, 8
    v_readfirstlane_b32 s56, v9
    v_mov_b32 v119, v9
    s_getreg_b32 s58, hwreg(HW_REG_XCC_ID, 0, 4)
    v_add_u32 v37, s58, v9
    s_and_b32 s58, s6, 15
    s_lshl2_add_u32 s58, s58, s34
    s_add_u32 s58, s58, 2048
    v_lshl_add_u32 v36, v0, 6, s58
    s_waitcnt vmcnt(0)
L_h1c_2:
    v_xor_b32 v92, v20, v92
    v_xor_b32 v93, v21, v93
    v_xor_b32 v94, v22, v94
    v_xor_b32 v95, v23, v95
    v_xor_b32 v96, v20, v96
    v_xor_b32 v97, v21, v97
    v_xor_b32 v98, v22, v98
    v_xor_b32 v99, v23, v99
    v_or3_b32 v16, v92, v93, v94
    v_or3_b32 v16, v16, v95, v96
    v_or3_b32 v16, v16, v97, v98
    v_bitop3_b32 v16, v16, v99, s57 bitop3:0x54
    v_cmp_ne_u32 vcc, 0, v16
    s_cbranch_vccnz L_h1_1
    s_mov_b64 exec, -1
    v_cvt_pk_bf16_f32 v44, v92, v93
    v_cvt_pk_bf16_f32 v45, v94, v95
    v_cvt_pk_bf16_f32 v48, v96, v97
    v_cvt_pk_bf16_f32 v49, v98, v99
    v_mov_b32_dpp v46, v44 quad_perm:[1,0,3,2] row_mask:0xf bank_mask:0xf
    v_mov_b32_dpp v47, v45 quad_perm:[1,0,3,2] row_mask:0xf bank_mask:0xf
    v_mov_b32_dpp v50, v48 quad_perm:[1,0,3,2] row_mask:0xf bank_mask:0xf
    v_mov_b32_dpp v51, v49 quad_perm:[1,0,3,2] row_mask:0xf bank_mask:0xf
    s_waitcnt lgkmcnt(0)
    v_mfma_f32_16x16x32_bf16 v[100:103], v[44:47], v[60:63], 0
    v_mfma_f32_16x16x32_bf16 v[108:111], v[44:47], v[76:79], 0
    v_mfma_f32_16x16x32_bf16 v[104:107], v[44:47], v[68:71], 0
    v_mfma_f32_16x16x32_bf16 v[112:115], v[44:47], v[84:87], 0
    v_mfma_f32_16x16x32_bf16 v[100:103], v[48:51], v[64:67], v[100:103]
    v_mfma_f32_16x16x32_bf16 v[108:111], v[48:51], v[80:83], v[108:111]
    v_mfma_f32_16x16x32_bf16 v[104:107], v[48:51], v[72:75], v[104:107]
    v_mfma_f32_16x16x32_bf16 v[112:115], v[48:51], v[88:91], v[112:115]
    s_nop 6
    v_add_f32 v28, v100, v106
    v_add_f32 v29, v108, v114
    s_nop 1
    v_permlane32_swap_b32 v28, v29
    v_add_f32 v28, v28, v29
    v_mul_f32 v29, 0x3e0293ee, v28
    v_mul_f32 v28, 0x3e0293ee, v28
    s_nop 1
    v_permlane16_swap_b32 v29, v28
    v_add_f32 v28, v28, v29
    v_cvt_pk_bf16_f32 v28, v28, v28
    ds_write_b16 v41, v28
    s_waitcnt lgkmcnt(0)
    s_barrier
    ds_read_b96 v[116:118], v42
    s_mov_b64 exec, 0xffffff
    s_waitcnt lgkmcnt(0)
    buffer_store_dwordx4 v[116:119], v40, s[36:39], s61 offen sc1
    s_mov_b64 exec, -1
    s_cmp_lg_u32 s4, 3
    s_cbranch_scc1 L_skip_3
    s_mov_b32 exec_hi, 0
    buffer_store_dword v37, v36, s[36:39], 0 offen
    s_mov_b32 exec_hi, -1
L_skip_3:
    s_barrier
    v_lshlrev_b32 v28, 16, v24
    v_and_b32 v29, 0xffff0000, v24
    v_lshlrev_b32 v30, 16, v25
    v_and_b32 v31, 0xffff0000, v25
    v_lshlrev_b32 v32, 16, v26
    v_and_b32 v33, 0xffff0000, v26
    v_lshlrev_b32 v34, 16, v27
    v_and_b32 v35, 0xffff0000, v27
    v_add_f32 v36, v28, v29
    v_add_f32 v37, v30, v31
    v_add_f32 v36, v36, v32
    v_add_f32 v37, v37, v33
    v_add_f32 v36, v36, v34
    v_add_f32 v37, v37, v35
    v_add_f32 v36, v36, v37
    s_nop 1
    v_add_f32_dpp v36, v36, v36 row_ror:8 row_mask:0xf bank_mask:0xf
    s_nop 1
    v_add_f32_dpp v36, v36, v36 row_ror:4 row_mask:0xf bank_mask:0xf
    s_nop 1
    v_add_f32_dpp v36, v36, v36 row_ror:2 row_mask:0xf bank_mask:0xf
    s_nop 1
    v_add_f32_dpp v36, v36, v36 row_ror:1 row_mask:0xf bank_mask:0xf
    v_mov_b32 v37, v36
    s_nop 1
    v_permlane16_swap_b32 v37, v36
    v_add_f32 v36, v36, v37
    v_mov_b32 v37, v36
    s_nop 1
    v_permlane32_swap_b32 v37, v36
    v_add_f32 v36, v36, v37
    v_mul_f32 v36, 0x3b000000, v36
    v_sub_f32 v37, v28, v36
    v_mul_f32 v38, v37, v37
    v_sub_f32 v37, v29, v36
    v_fmac_f32 v38, v37, v37
    v_sub_f32 v37, v30, v36
    v_fmac_f32 v38, v37, v37
    v_sub_f32 v37, v31, v36
    v_fmac_f32 v38, v37, v37
    v_sub_f32 v37, v32, v36
    v_fmac_f32 v38, v37, v37
    v_sub_f32 v37, v33, v36
    v_fmac_f32 v38, v37, v37
    v_sub_f32 v37, v34, v36
    v_fmac_f32 v38, v37, v37
    v_sub_f32 v37, v35, v36
    v_fmac_f32 v38, v37, v37
    s_nop 1
    v_add_f32_dpp v38, v38, v38 row_ror:8 row_mask:0xf bank_mask:0xf
    s_nop 1
    v_add_f32_dpp v38, v38, v38 row_ror:4 row_mask:0xf bank_mask:0xf
    s_nop 1
    v_add_f32_dpp v38, v38, v38 row_ror:2 row_mask:0xf bank_mask:0xf
    s_nop 1
    v_add_f32_dpp v38, v38, v38 row_ror:1 row_mask:0xf bank_mask:0xf
    v_mov_b32 v37, v38
    s_nop 1
    v_permlane16_swap_b32 v37, v38
    v_add_f32 v38, v38, v37
    v_mov_b32 v37, v38
    s_nop 1
    v_permlane32_swap_b32 v37, v38
    v_add_f32 v38, v38, v37
    v_mul_f32 v38, 0x3b000000, v38
    v_cvt_pk_bf16_f32 v36, v36, v36
    v_lshlrev_b32 v36, 16, v36
    v_cvt_pk_bf16_f32 v38, v38, v38
    v_lshlrev_b32 v38, 16, v38
    v_add_f32 v38, 0x3727c5ac, v38
    v_cvt_pk_bf16_f32 v38, v38, v38
    v_lshlrev_b32 v38, 16, v38
    v_sqrt_f32 v38, v38
    v_sub_f32 v28, v28, v36
    v_sub_f32 v29, v29, v36
    v_sub_f32 v30, v30, v36
    v_sub_f32 v31, v31, v36
    v_sub_f32 v32, v32, v36
    v_sub_f32 v33, v33, v36
    v_sub_f32 v34, v34, v36
    v_sub_f32 v35, v35, v36
    v_cvt_pk_bf16_f32 v38, v38, v38
    v_lshlrev_b32 v38, 16, v38
    v_rcp_f32 v38, v38
    v_cvt_pk_bf16_f32 v24, v28, v29
    v_cvt_pk_bf16_f32 v25, v30, v31
    v_cvt_pk_bf16_f32 v26, v32, v33
    v_cvt_pk_bf16_f32 v27, v34, v35
    v_lshlrev_b32 v28, 16, v24
    v_and_b32 v29, 0xffff0000, v24
    v_lshlrev_b32 v30, 16, v25
    v_and_b32 v31, 0xffff0000, v25
    v_lshlrev_b32 v32, 16, v26
    v_and_b32 v33, 0xffff0000, v26
    v_lshlrev_b32 v34, 16, v27
    v_and_b32 v35, 0xffff0000, v27
    v_mul_f32 v28, v28, v38
    v_mul_f32 v29, v29, v38
    v_mul_f32 v30, v30, v38
    v_mul_f32 v31, v31, v38
    v_mul_f32 v32, v32, v38
    v_mul_f32 v33, v33, v38
    v_mul_f32 v34, v34, v38
    v_mul_f32 v35, v35, v38
    v_cvt_pk_bf16_f32 v24, v28, v29
    v_cvt_pk_bf16_f32 v25, v30, v31
    v_cvt_pk_bf16_f32 v26, v32, v33
    v_cvt_pk_bf16_f32 v27, v34, v35
    v_add_u32 v39, 159232, v10
    ds_write_b128 v39, v[24:27]
    s_branch L_y
L_h1_1:
    s_mov_b64 exec, vcc
    s_add_u32 s33, s33, 1
    s_cmp_lt_u32 s33, 24
    s_cselect_b32 s62, 0, 8388608
    s_xor_b32 s60, s60, s62
    buffer_load_dwordx4 v[92:95], v43, s[36:39], s60 offen offset:0 sc1
    buffer_load_dwordx4 v[96:99], v43, s[36:39], s60 offen offset:128 sc1
    s_sub_u32 s7, s7, 1
    s_cbranch_scc1 L_exit
    s_waitcnt vmcnt(0)
    s_branch L_h1c_2
L_x:
    s_bfe_u32 s58, s6, 0x10003
    s_lshl1_add_u32 s96, s5, s58
    s_and_b32 s97, s6, 7
    v_and_b32 v28, 3, v1
    v_xor_b32 v28, v28, v2
    v_lshrrev_b32 v29, 2, v1
    v_lshl_add_u32 v28, v28, 2, v29
    v_lshlrev_b32 v28, 4, v28
    v_lshl_add_u32 v28, v1, 8, v28
    s_lshl_b32 s58, s4, 14
    v_add_u32 v28, s58, v28
    v_xor_b32 v40, 0, v28
    v_xor_b32 v41, 16, v28
    v_xor_b32 v42, 32, v28
    v_xor_b32 v43, 48, v28
    s_lshl_b32 s58, s3, 12
    s_add_u32 s58, s58, 65536
    v_add_u32 v30, s58, v10
    v_xor_b32 v44, 4096, v30
    v_xor_b32 v45, 8192, v30
    v_xor_b32 v46, 12288, v30
    s_lshl1_add_u32 s60, s96, s35
    s_lshl_b32 s60, s60, 15
    s_add_u32 s60, s60, 1048576
    s_lshl2_add_u32 s58, s97, s4
    s_lshl_b32 s58, s58, 10
    s_add_u32 s101, s58, s60
    s_lshr_b32 s59, s6, 3
    s_xor_b32 s100, s5, s59
    s_lshl3_add_u32 s100, s59, s100
    s_bfe_u32 s59, s6, 0x20001
    s_lshl2_add_u32 s100, s100, s59
    s_lshl1_add_u32 s58, s100, s35
    s_lshl_b32 s58, s58, 15
    s_lshl_b32 s59, s4, 8
    s_add_u32 s58, s58, s59
    v_lshlrev_b32 v31, 4, v1
    v_lshl_add_u32 v31, v2, 12, v31
    v_add_u32 v31, s58, v31
    s_and_b32 s60, s6, 1
    s_lshl_b32 s98, s60, 14
    s_xor_b32 s99, s98, 0x4000
    v_lshrrev_b32 v28, 3, v0
    v_and_b32 v29, 6, v28
    v_and_b32 v32, 7, v0
    v_xor_b32 v29, v29, v32
    v_lshlrev_b32 v28, 13, v28
    v_lshl_add_u32 v32, v29, 4, v28
    s_lshl3_add_u32 s58, s60, s3
    s_lshl_b32 s58, s58, 18
    s_lshl_b32 s59, s100, 7
    s_add_u32 s58, s58, s59
    v_add_u32 v32, s58, v32
    s_mul_i32 s60, s3, 6144
    s_lshr_b32 s58, s5, 1
    s_lshl_b32 s58, s58, 16
    s_add_u32 s60, s60, s58
    s_add_u32 s60, s60, 524288
    s_add_u32 s61, s60, 4096
    s_cmp_eq_u32 s35, 0
    s_cbranch_scc1 L_x0_4
    v_lshl_add_u32 v28, v2, 2, 0
    v_xor_b32 v28, v28, v1
    v_lshlrev_b32 v28, 4, v28
    v_lshl_add_u32 v28, v2, 10, v28
    v_add_u32 v36, 0, v28
    v_lshl_add_u32 v28, v2, 2, 1
    v_xor_b32 v28, v28, v1
    v_lshlrev_b32 v28, 4, v28
    v_lshl_add_u32 v28, v2, 10, v28
    v_add_u32 v37, 4096, v28
    v_lshl_add_u32 v28, v2, 2, 2
    v_xor_b32 v28, v28, v1
    v_lshlrev_b32 v28, 4, v28
    v_lshl_add_u32 v28, v2, 10, v28
    v_add_u32 v38, 8192, v28
    v_lshl_add_u32 v28, v2, 2, 3
    v_xor_b32 v28, v28, v1
    v_lshlrev_b32 v28, 4, v28
    v_lshl_add_u32 v28, v2, 10, v28
    v_add_u32 v39, 12288, v28
    s_lshl3_add_u32 s21, s96, s97
    s_lshl_b32 s21, s21, 16
    s_lshl_b32 s59, s4, 8
    s_add_u32 s21, s21, s59
    s_lshl_b32 s59, s4, 14
    s_mov_b32 s52, s10
    s_mov_b32 s53, s11
    s_mov_b32 s54, 0x800000
    s_mov_b32 s55, 0x20000
    s_barrier
    s_barrier
    s_barrier
    s_xor_b32 s20, s4, 1
    s_lshl_b32 s20, s20, 14
    s_add_u32 s20, s20, s21
    s_mov_b32 m0, s59
    s_add_u32 s59, s59, 1024
    buffer_load_dwordx4 v36, s[52:55], s20 offen lds
    s_mov_b32 m0, s59
    s_add_u32 s59, s59, 1024
    buffer_load_dwordx4 v37, s[52:55], s20 offen lds
    s_mov_b32 m0, s59
    s_add_u32 s59, s59, 1024
    buffer_load_dwordx4 v38, s[52:55], s20 offen lds
    s_mov_b32 m0, s59
    s_add_u32 s59, s59, 1024
    buffer_load_dwordx4 v39, s[52:55], s20 offen lds
    s_xor_b32 s20, s4, 2
    s_lshl_b32 s20, s20, 14
    s_add_u32 s20, s20, s21
    s_mov_b32 m0, s59
    s_add_u32 s59, s59, 1024
    buffer_load_dwordx4 v36, s[52:55], s20 offen lds
    s_mov_b32 m0, s59
    s_add_u32 s59, s59, 1024
    buffer_load_dwordx4 v37, s[52:55], s20 offen lds
    s_mov_b32 m0, s59
    s_add_u32 s59, s59, 1024
    buffer_load_dwordx4 v38, s[52:55], s20 offen lds
    s_mov_b32 m0, s59
    s_add_u32 s59, s59, 1024
    buffer_load_dwordx4 v39, s[52:55], s20 offen lds
    s_xor_b32 s20, s4, 3
    s_lshl_b32 s20, s20, 14
    s_add_u32 s20, s20, s21
    s_mov_b32 m0, s59
    s_add_u32 s59, s59, 1024
    buffer_load_dwordx4 v36, s[52:55], s20 offen lds
    s_mov_b32 m0, s59
    s_add_u32 s59, s59, 1024
    buffer_load_dwordx4 v37, s[52:55], s20 offen lds
    s_mov_b32 m0, s59
    s_add_u32 s59, s59, 1024
    buffer_load_dwordx4 v38, s[52:55], s20 offen lds
    s_mov_b32 m0, s59
    s_add_u32 s59, s59, 1024
    buffer_load_dwordx4 v39, s[52:55], s20 offen lds
    s_xor_b32 s20, s4, 0
    s_lshl_b32 s20, s20, 14
    s_add_u32 s20, s20, s21
    s_mov_b32 m0, s59
    s_add_u32 s59, s59, 1024
    buffer_load_dwordx4 v36, s[52:55], s20 offen lds
    s_mov_b32 m0, s59
    s_add_u32 s59, s59, 1024
    buffer_load_dwordx4 v37, s[52:55], s20 offen lds
    s_mov_b32 m0, s59
    s_add_u32 s59, s59, 1024
    buffer_load_dwordx4 v38, s[52:55], s20 offen lds
    s_mov_b32 m0, s59
    s_add_u32 s59, s59, 1024
    buffer_load_dwordx4 v39, s[52:55], s20 offen lds
    s_barrier
    ds_read_b32 v20, v3 offset:224
    s_waitcnt lgkmcnt(0)
    v_add_u32 v9, 0x9e3779b1, v20
    v_bfe_u32 v20, v9, 0, 8
    v_bfe_u32 v21, v9, 8, 8
    v_bfe_u32 v22, v9, 16, 8
    v_bfe_u32 v23, v9, 24, 8
    v_readfirstlane_b32 s56, v9
    s_branch L_x1_5
L_x0_4:
    s_barrier
    s_cmp_lg_u32 s4, 0
    s_cbranch_scc1 L_skip_6
    s_getreg_b32 s58, hwreg(HW_REG_HW_ID, 8, 1)
    s_lshl_b32 s58, s58, 10
    s_add_u32 s58, s58, s34
    s_add_u32 s58, s58, 2048
    s_movk_i32 s33, 15
    s_getreg_b32 s62, hwreg(HW_REG_XCC_ID, 0, 4)
    s_add_u32 s62, s62, s56
    s_mov_b32 s63, s62
L_sh_7:
    s_load_dwordx16 s[40:55], s[36:37], s58
    s_add_u32 s58, s58, 64
    s_waitcnt lgkmcnt(0)
    s_xor_b64 s[40:41], s[40:41], s[62:63]
    s_xor_b64 s[42:43], s[42:43], s[62:63]
    s_xor_b64 s[44:45], s[44:45], s[62:63]
    s_xor_b64 s[46:47], s[46:47], s[62:63]
    s_xor_b64 s[48:49], s[48:49], s[62:63]
    s_xor_b64 s[50:51], s[50:51], s[62:63]
    s_xor_b64 s[52:53], s[52:53], s[62:63]
    s_xor_b64 s[54:55], s[54:55], s[62:63]
    s_or_b64 s[40:41], s[40:41], s[42:43]
    s_or_b64 s[40:41], s[40:41], s[44:45]
    s_or_b64 s[40:41], s[40:41], s[46:47]
    s_or_b64 s[40:41], s[40:41], s[48:49]
    s_or_b64 s[40:41], s[40:41], s[50:51]
    s_or_b64 s[40:41], s[40:41], s[52:53]
    s_or_b64 s[40:41], s[40:41], s[54:55]
    s_cbranch_scc0 L_shd_9
    s_sub_u32 s33, s33, 1
    s_cbranch_scc0 L_sh_7
    s_sub_u32 s58, s58, 64
    v_lshlrev_b32 v28, 2, v1
    s_movk_i32 s33, 31
L_shv_8:
    buffer_load_dword v16, v28, s[36:39], s58 offen sc1
    s_waitcnt vmcnt(0)
    v_cmp_ne_u32 vcc, s62, v16
    s_cbranch_vccz L_shd_9
    s_sub_u32 s33, s33, 1
    s_cbranch_scc0 L_shv_8
L_shd_9:
    s_cmp_lt_i32 s33, 0
    s_cselect_b32 s58, 2, 1
    v_mov_b32 v28, s58
    ds_write_b32 v3, v28 offset:128
L_skip_6:
L_x1_5:
    s_barrier
    buffer_load_dwordx4 v[52:55], v10, s[36:39], s60 offen offset:0 sc1
    buffer_load_dwordx4 v[56:59], v10, s[36:39], s60 offen offset:1024 sc1
    buffer_load_dwordx4 v[60:63], v10, s[36:39], s60 offen offset:2048 sc1
    buffer_load_dwordx4 v[64:67], v10, s[36:39], s60 offen offset:3072 sc1
    buffer_load_dwordx4 v[68:71], v10, s[36:39], s61 offen offset:0 sc1
    buffer_load_dwordx4 v[72:75], v10, s[36:39], s61 offen offset:1024 sc1
    v_mov_b32 v175, v9
    s_mov_b32 s44, s16
    s_mov_b32 s45, s17
    s_mov_b32 s46, 0x400000
    s_mov_b32 s47, 0x20000
    s_mov_b32 s48, s18
    s_mov_b32 s49, s19
    s_mov_b32 s50, 0x400000
    s_mov_b32 s51, 0x20000
    s_waitcnt vmcnt(6) lgkmcnt(0)
    s_barrier
    ds_read_b32 v33, v3 offset:128
    ds_read_b128 v[76:79], v40 offset:0
    ds_read_b128 v[80:83], v41 offset:0
    ds_read_b128 v[84:87], v42 offset:0
    ds_read_b128 v[88:91], v43 offset:0
    ds_read_b128 v[92:95], v40 offset:4096
    ds_read_b128 v[96:99], v41 offset:4096
    ds_read_b128 v[100:103], v42 offset:4096
    ds_read_b128 v[104:107], v43 offset:4096
    ds_read_b128 v[108:111], v40 offset:8192
    ds_read_b128 v[112:115], v41 offset:8192
    ds_read_b128 v[116:119], v42 offset:8192
    ds_read_b128 v[120:123], v43 offset:8192
    ds_read_b128 v[124:127], v40 offset:12288
    ds_read_b128 v[128:131], v41 offset:12288
    ds_read_b128 v[132:135], v42 offset:12288
    ds_read_b128 v[136:139], v43 offset:12288
L_h2c_11:
    s_waitcnt vmcnt(5)
    v_xor_b32 v16, s56, v55
    s_waitcnt vmcnt(4)
    v_bitop3_b32 v16, v59, s56, v16 bitop3:0xbe
    s_waitcnt vmcnt(3)
    v_bitop3_b32 v16, v63, s56, v16 bitop3:0xbe
    v_mov_b32 v55, v60
    v_mov_b32 v59, v61
    s_waitcnt vmcnt(2)
    v_bitop3_b32 v16, v67, s56, v16 bitop3:0xbe
    s_waitcnt vmcnt(1)
    v_bitop3_b32 v16, v71, s56, v16 bitop3:0xbe
    s_waitcnt vmcnt(0)
    v_bitop3_b32 v16, v75, s56, v16 bitop3:0xbe
    v_mov_b32 v67, v72
    v_mov_b32 v71, v73
    v_cmp_ne_u32 vcc, 0, v16
    s_cbranch_vccnz L_h2_10
    s_mov_b64 exec, -1
    s_waitcnt lgkmcnt(0)
    v_mfma_f32_16x16x32_bf16 v[156:159], v[76:79], v[52:55], 0
    v_mfma_f32_16x16x32_bf16 v[156:159], v[80:83], v[56:59], v[156:159]
    v_mfma_f32_16x16x32_bf16 v[156:159], v[84:87], v[64:67], v[156:159]
    v_mfma_f32_16x16x32_bf16 v[156:159], v[88:91], v[68:71], v[156:159]
    v_mfma_f32_16x16x32_bf16 v[160:163], v[92:95], v[52:55], 0
    v_mfma_f32_16x16x32_bf16 v[160:163], v[96:99], v[56:59], v[160:163]
    v_mfma_f32_16x16x32_bf16 v[160:163], v[100:103], v[64:67], v[160:163]
    v_mfma_f32_16x16x32_bf16 v[160:163], v[104:107], v[68:71], v[160:163]
    v_mfma_f32_16x16x32_bf16 v[164:167], v[108:111], v[52:55], 0
    v_mfma_f32_16x16x32_bf16 v[164:167], v[112:115], v[56:59], v[164:167]
    v_mfma_f32_16x16x32_bf16 v[164:167], v[116:119], v[64:67], v[164:167]
    v_mfma_f32_16x16x32_bf16 v[164:167], v[120:123], v[68:71], v[164:167]
    ds_write_b128 v30, v[156:159] offset:0
    v_mfma_f32_16x16x32_bf16 v[168:171], v[124:127], v[52:55], 0
    v_mfma_f32_16x16x32_bf16 v[168:171], v[128:131], v[56:59], v[168:171]
    v_mfma_f32_16x16x32_bf16 v[168:171], v[132:135], v[64:67], v[168:171]
    v_mfma_f32_16x16x32_bf16 v[168:171], v[136:139], v[68:71], v[168:171]
    ds_write_b128 v30, v[160:163] offset:1024
    buffer_store_dword v9, v6, s[36:39], s32 offen offset:0
    s_nop 0
    ds_write_b128 v30, v[164:167] offset:2048
    ds_write_b32 v4, v5 offset:0
    ds_read_b128 v[16:19], v7 offset:0
    ds_read_b128 v[140:143], v44 offset:0
    ds_read_b128 v[144:147], v45 offset:1024
    ds_read_b128 v[148:151], v46 offset:2048
    s_waitcnt lgkmcnt(0)
    v_min3_u32 v16, v16, v17, v18
    v_min_u32 v16, v16, v19
    v_cmp_ne_u32 vcc, 0, v16
    s_cbranch_vccnz L_wfd_13
L_wf_12:
    s_sub_u32 s7, s7, 1
    s_cbranch_scc1 L_exit
    ds_read_b128 v[16:19], v7 offset:0
    s_waitcnt lgkmcnt(0)
    v_min3_u32 v16, v16, v17, v18
    v_min_u32 v16, v16, v19
    v_cmp_ne_u32 vcc, 0, v16
    s_cbranch_vccz L_wf_12
    ds_read_b128 v[140:143], v44 offset:0
    ds_read_b128 v[144:147], v45 offset:1024
    ds_read_b128 v[148:151], v46 offset:2048
    s_waitcnt lgkmcnt(0)
L_wfd_13:
    v_pk_add_f32 v[168:169], v[168:169], v[140:141]
    v_pk_add_f32 v[144:145], v[144:145], v[148:149]
    v_pk_add_f32 v[170:171], v[170:171], v[142:143]
    v_pk_add_f32 v[146:147], v[146:147], v[150:151]
    v_pk_add_f32 v[168:169], v[168:169], v[144:145]
    v_pk_add_f32 v[170:171], v[170:171], v[146:147]
    v_max3_f32 v174, v168, v169, v170
    v_max_f32 v174, v174, v171
    v_ceil_f32 v174, v174
    v_sub_f32 v168, v168, v174
    v_sub_f32 v169, v169, v174
    v_sub_f32 v170, v170, v174
    v_sub_f32 v171, v171, v174
    v_exp_f32 v168, v168
    v_exp_f32 v169, v169
    v_exp_f32 v170, v170
    v_exp_f32 v171, v171
    v_cmp_ne_u32 vcc, 1, v33
    v_cvt_pk_bf16_f32 v172, v168, v169
    v_cvt_pk_bf16_f32 v173, v170, v171
    s_cbranch_vccnz L_pfar_14
    buffer_store_dwordx4 v[172:175], v10, s[36:39], s101 offen
L_pdone_15:
    s_barrier
    buffer_load_dwordx4 v[176:179], v31, s[48:51], s98 offen offset:0
    buffer_load_dwordx4 v[180:183], v31, s[48:51], s98 offen offset:1024
    buffer_load_dwordx4 v[184:187], v31, s[48:51], s98 offen offset:2048
    buffer_load_dwordx4 v[188:191], v31, s[48:51], s98 offen offset:3072
    s_mov_b32 s58, 0
    s_lshl_b32 s20, s3, 12
    s_add_u32 s20, s20, 100352
    s_mov_b32 s59, s20
    s_mov_b32 m0, s59
    s_add_u32 s59, s59, 1024
    buffer_load_dwordx4 v32, s[44:47], s58 offen lds
    s_add_u32 s58, s58, 65536
    s_mov_b32 m0, s59
    s_add_u32 s59, s59, 1024
    buffer_load_dwordx4 v32, s[44:47], s58 offen lds
    s_add_u32 s58, s58, 65536
    s_mov_b32 m0, s59
    s_add_u32 s59, s59, 1024
    buffer_load_dwordx4 v32, s[44:47], s58 offen lds
    s_add_u32 s58, s58, 65536
    s_mov_b32 m0, s59
    s_nop 0
    buffer_load_dwordx4 v32, s[44:47], s58 offen lds
    v_lshrrev_b32 v28, 2, v0
    v_lshlrev_b32 v28, 7, v28
    v_and_b32 v29, 3, v0
    v_lshl_add_u32 v28, v29, 3, v28
    v_bfe_u32 v29, v0, 3, 2
    v_lshl_add_u32 v28, v29, 5, v28
    v_add_u32 v28, s20, v28
    v_xor_b32 v40, 0, v28
    v_xor_b32 v41, 32, v28
    v_xor_b32 v42, 64, v28
    v_xor_b32 v43, 96, v28
    s_and_b32 s21, s6, 1
    s_andn2_b32 s60, s100, 1
    s_add_u32 s60, s60, s21
    s_lshr_b32 s58, s3, 1
    s_lshl2_add_u32 s60, s60, s58
    s_lshl_b32 s60, s60, 12
    s_and_b32 s58, s3, 1
    s_lshl_b32 s58, s58, 7
    s_add_u32 s60, s60, s58
    s_add_u32 s60, s60, 2097152
    s_lshl_b32 s20, s3, 11
    s_mov_b32 s100, 0x05040100
    s_mov_b32 s101, 0x07060302
    v_and_b32 v28, 7, v0
    v_xor_b32 v28, v28, v2
    v_lshlrev_b32 v28, 4, v28
    v_lshrrev_b32 v29, 3, v0
    v_lshl_add_u32 v36, v29, 8, v28
    v_xor_b32 v28, 64, v36
    v_add_u32 v37, 0x400, v28
    v_lshrrev_b32 v28, 1, v1
    v_xor_b32 v28, v28, v2
    v_lshlrev_b32 v28, 4, v28
    v_lshl_add_u32 v28, v1, 7, v28
    v_add_u32 v38, s20, v28
    v_xor_b32 v39, 64, v38
    v_mul_u32_u24 v28, 80, v1
    v_lshl_add_u32 v28, v2, 4, v28
    s_lshl1_add_u32 s58, s3, 133120
    v_add_u32 v44, s58, v28
    s_lshl1_add_u32 s58, s35, s21
    s_mul_i32 s59, s58, 1280
    s_add_u32 s59, s59, 133120
    v_add_u32 v48, s59, v28
    s_xor_b32 s58, s58, 1
    s_mul_i32 s59, s58, 1280
    s_add_u32 s59, s59, 133120
    v_add_u32 v49, s59, v28
    s_xor_b32 s58, s58, 1
    v_and_b32 v28, 8, v1
    v_add_lshl_u32 v34, v28, v1, 4
    s_lshl3_add_u32 s58, s2, s3
    s_lshl_b32 s61, s58, 9
    s_add_u32 s61, s61, 3145728
    v_mov_b32 v148, 0x3f803f80
    v_mov_b32 v152, 0x3e803e80
    v_mov_b32 v149, 0x3f803f80
    v_mov_b32 v153, 0x3e803e80
    v_mov_b32 v150, 0x3f803f80
    v_mov_b32 v154, 0x3e803e80
    v_mov_b32 v151, 0x3f803f80
    v_mov_b32 v155, 0x3e803e80
    v_mov_b32 v145, 0
    v_mov_b32 v146, 0
    v_mov_b32 v147, 0
    s_cmp_lg_u32 s58, 1
    s_cbranch_scc1 L_skip_16
    s_mov_b64 exec, 1
    buffer_store_dword v9, v6, s[36:39], 0 offen sc1
    s_mov_b64 exec, -1
L_skip_16:
    s_waitcnt vmcnt(0)
    buffer_load_dwordx4 v[192:195], v31, s[48:51], s99 offen offset:0
    buffer_load_dwordx4 v[196:199], v31, s[48:51], s99 offen offset:1024
    buffer_load_dwordx4 v[200:203], v31, s[48:51], s99 offen offset:2048
    buffer_load_dwordx4 v[204:207], v31, s[48:51], s99 offen offset:3072
    ds_read_b64_tr_b16 v[108:109], v40 offset:0
    ds_read_b64_tr_b16 v[110:111], v40 offset:2048
    ds_read_b64_tr_b16 v[112:113], v41 offset:0
    ds_read_b64_tr_b16 v[114:115], v41 offset:2048
    ds_read_b64_tr_b16 v[116:117], v42 offset:0
    ds_read_b64_tr_b16 v[118:119], v42 offset:2048
    ds_read_b64_tr_b16 v[120:121], v43 offset:0
    ds_read_b64_tr_b16 v[122:123], v43 offset:2048
    v_perm_b32 v76, v180, v176, s100
    v_perm_b32 v77, v188, v184, s100
    v_perm_b32 v80, v180, v176, s101
    v_perm_b32 v81, v188, v184, s101
    v_perm_b32 v84, v181, v177, s100
    v_perm_b32 v85, v189, v185, s100
    v_perm_b32 v88, v181, v177, s101
    v_perm_b32 v89, v189, v185, s101
    v_perm_b32 v92, v182, v178, s100
    v_perm_b32 v93, v190, v186, s100
    v_perm_b32 v96, v182, v178, s101
    v_perm_b32 v97, v190, v186, s101
    v_perm_b32 v100, v183, v179, s100
    v_perm_b32 v101, v191, v187, s100
    v_perm_b32 v104, v183, v179, s101
    v_perm_b32 v105, v191, v187, s101
    s_cmp_lg_u32 s3, 0
    s_cbranch_scc1 L_skip_17
    s_lshr_b32 s59, s6, 3
    s_getreg_b32 s58, hwreg(HW_REG_HW_ID, 8, 1)
    s_lshl_b32 s58, s58, 10
    s_add_u32 s58, s58, s34
    s_add_u32 s58, s58, 4096
    s_lshl_b32 s59, s59, 11
    s_add_u32 s58, s58, s59
    s_movk_i32 s33, 15
    s_getreg_b32 s62, hwreg(HW_REG_XCC_ID, 0, 4)
    s_add_u32 s62, s62, s56
    s_mov_b32 s63, s62
L_sh_18:
    s_load_dwordx16 s[40:55], s[36:37], s58
    s_add_u32 s58, s58, 64
    s_waitcnt lgkmcnt(0)
    s_xor_b64 s[40:41], s[40:41], s[62:63]
    s_xor_b64 s[42:43], s[42:43], s[62:63]
    s_xor_b64 s[44:45], s[44:45], s[62:63]
    s_xor_b64 s[46:47], s[46:47], s[62:63]
    s_xor_b64 s[48:49], s[48:49], s[62:63]
    s_xor_b64 s[50:51], s[50:51], s[62:63]
    s_xor_b64 s[52:53], s[52:53], s[62:63]
    s_xor_b64 s[54:55], s[54:55], s[62:63]
    s_or_b64 s[40:41], s[40:41], s[42:43]
    s_or_b64 s[40:41], s[40:41], s[44:45]
    s_or_b64 s[40:41], s[40:41], s[46:47]
    s_or_b64 s[40:41], s[40:41], s[48:49]
    s_or_b64 s[40:41], s[40:41], s[50:51]
    s_or_b64 s[40:41], s[40:41], s[52:53]
    s_or_b64 s[40:41], s[40:41], s[54:55]
    s_cbranch_scc0 L_shd_20
    s_sub_u32 s33, s33, 1
    s_cbranch_scc0 L_sh_18
    s_sub_u32 s58, s58, 64
    v_lshlrev_b32 v28, 2, v1
    s_movk_i32 s33, 31
L_shv_19:
    buffer_load_dword v16, v28, s[36:39], s58 offen sc1
    s_waitcnt vmcnt(0)
    v_cmp_ne_u32 vcc, s62, v16
    s_cbranch_vccz L_shd_20
    s_sub_u32 s33, s33, 1
    s_cbranch_scc0 L_shv_19
L_shd_20:
    s_movk_i32 m0, 0
    s_add_u32 s58, s60, 0
    buffer_load_dwordx4 v36, s[36:39], s58 offen offset:0 sc1 lds
    buffer_load_dwordx4 v37, s[36:39], s58 offen offset:1024 sc1 lds
    s_movk_i32 m0, 2048
    s_add_u32 s58, s60, 128
    buffer_load_dwordx4 v36, s[36:39], s58 offen offset:0 sc1 lds
    buffer_load_dwordx4 v37, s[36:39], s58 offen offset:1024 sc1 lds
    s_movk_i32 m0, 4096
    s_add_u32 s58, s60, 4096
    buffer_load_dwordx4 v36, s[36:39], s58 offen offset:0 sc1 lds
    buffer_load_dwordx4 v37, s[36:39], s58 offen offset:1024 sc1 lds
    s_movk_i32 m0, 6144
    s_add_u32 s58, s60, 4224
    buffer_load_dwordx4 v36, s[36:39], s58 offen offset:0 sc1 lds
    buffer_load_dwordx4 v37, s[36:39], s58 offen offset:1024 sc1 lds
    s_movk_i32 m0, 8192
    s_add_u32 s58, s60, 8192
    buffer_load_dwordx4 v36, s[36:39], s58 offen offset:0 sc1 lds
    buffer_load_dwordx4 v37, s[36:39], s58 offen offset:1024 sc1 lds
    s_movk_i32 m0, 10240
    s_add_u32 s58, s60, 8320
    buffer_load_dwordx4 v36, s[36:39], s58 offen offset:0 sc1 lds
    buffer_load_dwordx4 v37, s[36:39], s58 offen offset:1024 sc1 lds
    s_movk_i32 m0, 12288
    s_add_u32 s58, s60, 12288
    buffer_load_dwordx4 v36, s[36:39], s58 offen offset:0 sc1 lds
    buffer_load_dwordx4 v37, s[36:39], s58 offen offset:1024 sc1 lds
    s_movk_i32 m0, 14336
    s_add_u32 s58, s60, 12416
    buffer_load_dwordx4 v36, s[36:39], s58 offen offset:0 sc1 lds
    buffer_load_dwordx4 v37, s[36:39], s58 offen offset:1024 sc1 lds
    s_waitcnt vmcnt(0)
L_skip_17:
    s_barrier
L_h3c_22:
    ds_read_b128 v[124:127], v38
    ds_read_b128 v[128:131], v39
    s_waitcnt lgkmcnt(1)
    v_max_f32_dpp v72, v126, v126 row_ror:8 row_mask:0xf bank_mask:0xf
    v_mov_b32 v73, v126
    s_waitcnt lgkmcnt(0)
    v_max_f32_dpp v72, v72, v72 row_ror:4 row_mask:0xf bank_mask:0xf
    v_xor_b32 v16, s56, v127
    v_bitop3_b32 v16, v131, s56, v16 bitop3:0xbe
    v_cmp_ne_u32 vcc, 0, v16
    s_cbranch_vccnz L_h3_21
    v_max_f32_dpp v72, v72, v72 row_ror:2 row_mask:0xf bank_mask:0xf
    v_mov_b32 v126, v128
    v_mov_b32 v127, v129
    v_max_f32_dpp v72, v72, v72 row_ror:1 row_mask:0xf bank_mask:0xf
    v_sub_f32 v72, v73, v72
    v_mfma_f32_16x16x32_bf16 v[156:159], v[124:127], v[108:111], 0
    v_exp_f32 v72, v72
    v_mfma_f32_16x16x32_bf16 v[160:163], v[124:127], v[112:115], 0
    v_cvt_pk_bf16_f32 v144, v72, 0
    v_mul_f32 v72, v72, v130
    v_mfma_f32_16x16x32_bf16 v[164:167], v[124:127], v[116:119], 0
    v_mfma_f32_16x16x32_bf16 v[60:63], v[144:147], v[152:155], 0
    v_mfma_f32_16x16x32_bf16 v[168:171], v[124:127], v[120:123], 0
    v_add_f32_dpp v72, v72, v72 row_ror:8 row_mask:0xf bank_mask:0xf
    s_nop 1
    v_add_f32_dpp v72, v72, v72 row_ror:4 row_mask:0xf bank_mask:0xf
    s_nop 1
    v_add_f32_dpp v72, v72, v72 row_ror:2 row_mask:0xf bank_mask:0xf
    v_pk_mul_f32 v[156:157], v[60:61], v[156:157]
    v_pk_mul_f32 v[160:161], v[60:61], v[160:161]
    v_pk_mul_f32 v[164:165], v[60:61], v[164:165]
    v_pk_mul_f32 v[168:169], v[60:61], v[168:169]
    v_pk_fma_f32 v[156:157], v[62:63], v[158:159], v[156:157]
    v_pk_fma_f32 v[160:161], v[62:63], v[162:163], v[160:161]
    v_pk_fma_f32 v[164:165], v[62:63], v[166:167], v[164:165]
    v_pk_fma_f32 v[168:169], v[62:63], v[170:171], v[168:169]
    v_add_f32 v68, v156, v157
    v_add_f32 v69, v160, v161
    v_add_f32 v70, v164, v165
    v_add_f32 v71, v168, v169
    v_cvt_pk_bf16_f32 v68, v68, v69
    ds_write_b16 v44, v68 offset:0
    ds_write_b16_d16_hi v44, v68 offset:1280
    v_cvt_pk_bf16_f32 v70, v70, v71
    ds_write_b16 v44, v70 offset:2560
    ds_write_b16_d16_hi v44, v70 offset:3840
    v_add_f32_dpp v72, v72, v72 row_ror:1 row_mask:0xf bank_mask:0xf
    v_rcp_f32 v72, v72
    s_waitcnt lgkmcnt(0)
    s_barrier
    ds_read_b128 v[124:127], v48
    ds_read_b128 v[128:131], v49
    buffer_store_dword v9, v6, s[36:39], s32 offen offset:512
    s_waitcnt vmcnt(1)
    v_perm_b32 v78, v196, v192, s100
    v_perm_b32 v79, v204, v200, s100
    v_perm_b32 v82, v196, v192, s101
    v_perm_b32 v83, v204, v200, s101
    v_perm_b32 v86, v197, v193, s100
    v_perm_b32 v87, v205, v201, s100
    v_perm_b32 v90, v197, v193, s101
    v_perm_b32 v91, v205, v201, s101
    s_waitcnt lgkmcnt(0)
    v_mfma_f32_16x16x32_bf16 v[156:159], v[124:127], v[148:151], 0
    v_mfma_f32_16x16x32_bf16 v[160:163], v[128:131], v[148:151], 0
    v_perm_b32 v94, v198, v194, s100
    v_perm_b32 v95, v206, v202, s100
    v_perm_b32 v98, v198, v194, s101
    v_perm_b32 v99, v206, v202, s101
    v_perm_b32 v102, v199, v195, s100
    v_perm_b32 v103, v207, v203, s100
    v_perm_b32 v106, v199, v195, s101
    v_perm_b32 v107, v207, v203, s101
    v_pk_mul_f32 v[156:157], v[72:73], v[156:157] op_sel_hi:[0,1]
    v_pk_mul_f32 v[158:159], v[72:73], v[158:159] op_sel_hi:[0,1]
    v_pk_mul_f32 v[160:161], v[72:73], v[160:161] op_sel_hi:[0,1]
    v_pk_mul_f32 v[162:163], v[72:73], v[162:163] op_sel_hi:[0,1]
    v_cvt_pk_bf16_f32 v140, v156, v157
    v_cvt_pk_bf16_f32 v141, v158, v159
    v_cvt_pk_bf16_f32 v142, v160, v161
    v_cvt_pk_bf16_f32 v143, v162, v163
    s_nop 1
    v_mfma_f32_16x16x32_bf16 v[176:179], v[140:143], v[76:79], 0
    v_mfma_f32_16x16x32_bf16 v[180:183], v[140:143], v[80:83], 0
    v_mfma_f32_16x16x32_bf16 v[184:187], v[140:143], v[84:87], 0
    v_mfma_f32_16x16x32_bf16 v[188:191], v[140:143], v[88:91], 0
    v_mfma_f32_16x16x32_bf16 v[192:195], v[140:143], v[92:95], 0
    v_mfma_f32_16x16x32_bf16 v[196:199], v[140:143], v[96:99], 0
    v_mfma_f32_16x16x32_bf16 v[200:203], v[140:143], v[100:103], 0
    v_mfma_f32_16x16x32_bf16 v[204:207], v[140:143], v[104:107], 0
    buffer_store_dword v9, v6, s[36:39], s32 offen offset:1024
    s_mov_b64 exec, 0xffff
    v_and_or_b32 v52, v176, s57, v20
    v_and_or_b32 v53, v180, s57, v21
    v_and_or_b32 v54, v184, s57, v22
    v_and_or_b32 v55, v188, s57, v23
    buffer_store_dwordx4 v[52:55], v34, s[36:39], s61 offen offset:0 sc1
    v_and_or_b32 v56, v192, s57, v20
    v_and_or_b32 v57, v196, s57, v21
    v_and_or_b32 v58, v200, s57, v22
    v_and_or_b32 v59, v204, s57, v23
    buffer_store_dwordx4 v[56:59], v34, s[36:39], s61 offen offset:128 sc1
    s_endpgm
L_h2_10:
    s_mov_b64 exec, vcc
    buffer_load_dwordx4 v[52:55], v10, s[36:39], s60 offen offset:0 sc1
    buffer_load_dwordx4 v[56:59], v10, s[36:39], s60 offen offset:1024 sc1
    buffer_load_dwordx4 v[60:63], v10, s[36:39], s60 offen offset:2048 sc1
    buffer_load_dwordx4 v[64:67], v10, s[36:39], s60 offen offset:3072 sc1
    buffer_load_dwordx4 v[68:71], v10, s[36:39], s61 offen offset:0 sc1
    buffer_load_dwordx4 v[72:75], v10, s[36:39], s61 offen offset:1024 sc1
    s_sub_u32 s7, s7, 1
    s_cbranch_scc1 L_exit
    s_waitcnt vmcnt(0)
    s_branch L_h2c_11
L_pfar_14:
    buffer_store_dwordx4 v[172:175], v10, s[36:39], s101 offen sc1
    s_branch L_pdone_15
L_h3_21:
    s_mov_b32 m0, s20
    s_nop 0
    buffer_load_dwordx4 v36, s[36:39], s60 offen offset:0 sc1 lds
    buffer_load_dwordx4 v37, s[36:39], s60 offen offset:1024 sc1 lds
    s_sub_u32 s7, s7, 1
    s_cbranch_scc1 L_exit
    s_waitcnt vmcnt(0)
    s_branch L_h3c_22
L_y:
    s_bfe_u32 s58, s6, 0x10003
    s_lshl1_add_u32 s96, s5, s58
    s_and_b32 s97, s6, 7
    s_lshl_b32 s61, s4, 14
    v_lshrrev_b32 v28, 2, v0
    v_lshlrev_b32 v28, 7, v28
    v_and_b32 v29, 3, v0
    v_lshl_add_u32 v28, v29, 3, v28
    v_bfe_u32 v29, v0, 3, 2
    v_lshl_add_u32 v28, v29, 5, v28
    v_add_u32 v28, s61, v28
    v_xor_b32 v204, 0, v28
    v_xor_b32 v205, 32, v28
    v_xor_b32 v206, 64, v28
    v_xor_b32 v207, 96, v28
    s_mul_i32 s98, s5, 5
    s_min_u32 s58, s5, 3
    s_add_u32 s98, s98, s58
    s_cmp_lt_u32 s5, 3
    s_cselect_b32 s99, 6, 5
    s_and_b32 s20, s6, 15
    s_add_u32 s21, s98, s3
    s_lshl4_add_u32 s21, s21, s20
    s_lshl_b32 s21, s21, 7
    s_add_u32 s21, s21, 196608
    s_lshl_b32 s58, s20, 6
    s_add_u32 s58, s58, 159232
    v_lshl_add_u32 v32, v2, 4, s58
    s_lshl_b32 s58, s3, 11
    s_add_u32 s58, s58, 100352
    v_lshl_add_u32 v31, v1, 4, s58
    v_lshl_add_u32 v31, v2, 9, v31
    v_lshlrev_b32 v30, 4, v1
    v_lshl_add_u32 v30, v2, 5, v30
    s_lshl3_add_u32 s58, s5, s97
    s_and_b32 s59, s6, 8
    s_lshl4_add_u32 s58, s58, s59
    v_and_b32 v28, 1, v2
    v_lshlrev_b32 v28, 2, v28
    v_and_b32 v35, 2, v2
    v_add3_u32 v35, v35, v28, s58
    s_lshl_b32 s58, s3, 12
    s_add_u32 s58, s58, 65536
    v_xor_b32 v28, v1, v2
    v_lshl_add_u32 v28, v28, 4, s58
    v_lshl_add_u32 v28, v2, 8, v28
    v_xor_b32 v208, 0, v28
    v_xor_b32 v209, 64, v28
    v_xor_b32 v210, 128, v28
    v_xor_b32 v211, 192, v28
    v_lshl_add_u32 v29, s4, 2, v2
    s_lshl_b32 s58, s35, 14
    s_add_u32 s58, s58, 65536
    v_xor_b32 v28, v29, v1
    v_lshl_add_u32 v28, v28, 4, s58
    v_lshl_add_u32 v36, v1, 8, v28
    s_lshl_b32 s58, s35, 9
    s_add_u32 s58, s58, 160768
    v_lshl_add_u32 v38, v29, 5, s58
    s_lshl3_add_u32 s58, s4, s58
    v_lshl_add_u32 v37, v1, 5, s58
    s_lshl_b32 s58, s35, 7
    s_add_u32 s58, s58, s97
    s_lshl4_add_u32 s58, s58, s96
    s_lshl_b32 s58, s58, 8
    s_add_u32 s58, s58, 2097152
    v_lshl_add_u32 v28, v29, 15, s58
    v_lshl_add_u32 v39, v1, 4, v28
    v_mov_b32 v184, 0x3f803f80
    v_mov_b32 v185, 0x3f803f80
    v_mov_b32 v186, 0x3f803f80
    v_mov_b32 v187, 0x3f803f80
    s_and_b32 s58, s6, 8
    s_lshl1_add_u32 s58, s4, s58
    s_lshl_b32 s58, s58, 4
    v_and_b32 v28, 7, v0
    v_lshl_add_u32 v40, v28, 2, s58
    s_cmp_lg_u32 s35, 1
    s_cbranch_scc1 L_skip_23
    s_mov_b32 s52, s10
    s_mov_b32 s53, s11
    s_mov_b32 s54, 0x800000
    s_mov_b32 s55, 0x20000
    s_mov_b32 s48, s22
    s_mov_b32 s49, s23
    s_mov_b32 s50, 0x158000
    s_mov_b32 s51, 0x20000
    v_lshrrev_b32 v28, 3, v0
    v_and_b32 v29, 6, v28
    v_and_b32 v34, 7, v0
    v_xor_b32 v29, v29, v34
    v_lshlrev_b32 v28, 10, v28
    v_lshl_add_u32 v34, v29, 4, v28
    s_lshl2_add_u32 s60, s96, s4
    s_lshl_b32 s60, s60, 17
    s_lshl_b32 s59, s97, 7
    s_add_u32 s60, s60, s59
    v_lshrrev_b32 v33, 2, v0
    v_mul_u32_u24 v33, 2752, v33
    v_and_b32 v29, 3, v0
    v_lshl_add_u32 v33, v29, 4, v33
    s_lshl4_add_u32 s58, s96, s97
    s_lshl2_add_u32 s58, s58, s4
    s_lshl_b32 s58, s58, 10
    s_add_u32 s58, s58, 1048576
    v_and_b32 v28, 7, v0
    v_lshl_add_u32 v28, v28, 7, s58
    v_bfe_u32 v29, v0, 3, 1
    v_lshl_add_u32 v200, v29, 15, v28
    s_sub_u32 s58, s21, 8192
    v_and_b32 v29, 1, v0
    v_lshl_add_u32 v28, v29, 13, s58
    v_cmp_gt_u32 vcc, 16, v0
    s_nop 1
    v_cndmask_b32 v200, v28, v200, vcc
    s_mov_b32 s44, s18
    s_mov_b32 s45, s19
    s_mov_b32 s46, 0x400000
    s_mov_b32 s47, 0x20000
    s_lshl2_add_u32 s58, s20, s4
    s_lshl_b32 s58, s58, 10
    s_and_b32 s59, s5, 1
    s_mul_i32 s59, s59, 7
    s_add_u32 s59, s59, s5
    s_lshl_b32 s59, s59, 18
    s_add_u32 s58, s58, s59
    s_add_u32 s58, s58, 0x30000
    v_lshl_add_u32 v41, v0, 7, s58
    s_barrier
    s_barrier
    s_lshr_b32 s58, s97, 1
    s_xor_b32 s58, s58, 0
    s_lshl_b32 s59, s58, 11
    s_add_u32 s59, s59, s61
    s_lshl_b32 s58, s58, 14
    s_add_u32 s58, s58, s60
    s_mov_b32 m0, s59
    s_add_u32 s59, s59, 1024
    buffer_load_dwordx4 v34, s[52:55], s58 offen lds
    s_add_u32 s58, s58, 8192
    s_mov_b32 m0, s59
    s_nop 0
    buffer_load_dwordx4 v34, s[52:55], s58 offen lds
    s_add_u32 s58, s58, 57344
    s_add_u32 s59, s59, 7168
    s_mov_b32 m0, s59
    s_add_u32 s59, s59, 1024
    buffer_load_dwordx4 v34, s[52:55], s58 offen lds
    s_add_u32 s58, s58, 8192
    s_mov_b32 m0, s59
    s_nop 0
    buffer_load_dwordx4 v34, s[52:55], s58 offen lds
    s_lshr_b32 s58, s97, 1
    s_xor_b32 s58, s58, 3
    s_lshl_b32 s59, s58, 11
    s_add_u32 s59, s59, s61
    s_lshl_b32 s58, s58, 14
    s_add_u32 s58, s58, s60
    s_mov_b32 m0, s59
    s_add_u32 s59, s59, 1024
    buffer_load_dwordx4 v34, s[52:55], s58 offen lds
    s_add_u32 s58, s58, 8192
    s_mov_b32 m0, s59
    s_nop 0
    buffer_load_dwordx4 v34, s[52:55], s58 offen lds
    s_add_u32 s58, s58, 57344
    s_add_u32 s59, s59, 7168
    s_mov_b32 m0, s59
    s_add_u32 s59, s59, 1024
    buffer_load_dwordx4 v34, s[52:55], s58 offen lds
    s_add_u32 s58, s58, 8192
    s_mov_b32 m0, s59
    s_nop 0
    buffer_load_dwordx4 v34, s[52:55], s58 offen lds
    s_lshr_b32 s58, s97, 1
    s_xor_b32 s58, s58, 2
    s_lshl_b32 s59, s58, 11
    s_add_u32 s59, s59, s61
    s_lshl_b32 s58, s58, 14
    s_add_u32 s58, s58, s60
    s_mov_b32 m0, s59
    s_add_u32 s59, s59, 1024
    buffer_load_dwordx4 v34, s[52:55], s58 offen lds
    s_add_u32 s58, s58, 8192
    s_mov_b32 m0, s59
    s_nop 0
    buffer_load_dwordx4 v34, s[52:55], s58 offen lds
    s_add_u32 s58, s58, 57344
    s_add_u32 s59, s59, 7168
    s_mov_b32 m0, s59
    s_add_u32 s59, s59, 1024
    buffer_load_dwordx4 v34, s[52:55], s58 offen lds
    s_add_u32 s58, s58, 8192
    s_mov_b32 m0, s59
    s_nop 0
    buffer_load_dwordx4 v34, s[52:55], s58 offen lds
    s_lshr_b32 s58, s97, 1
    s_xor_b32 s58, s58, 1
    s_lshl_b32 s59, s58, 11
    s_add_u32 s59, s59, s61
    s_lshl_b32 s58, s58, 14
    s_add_u32 s58, s58, s60
    s_mov_b32 m0, s59
    s_add_u32 s59, s59, 1024
    buffer_load_dwordx4 v34, s[52:55], s58 offen lds
    s_add_u32 s58, s58, 8192
    s_mov_b32 m0, s59
    s_nop 0
    buffer_load_dwordx4 v34, s[52:55], s58 offen lds
    s_add_u32 s58, s58, 57344
    s_add_u32 s59, s59, 7168
    s_mov_b32 m0, s59
    s_add_u32 s59, s59, 1024
    buffer_load_dwordx4 v34, s[52:55], s58 offen lds
    s_add_u32 s58, s58, 8192
    s_mov_b32 m0, s59
    s_nop 0
    buffer_load_dwordx4 v34, s[52:55], s58 offen lds
    ds_read_b32 v20, v3 offset:224
    s_waitcnt lgkmcnt(0)
    v_add_u32 v9, 0x9e3779b1, v20
    v_bfe_u32 v20, v9, 0, 8
    v_bfe_u32 v21, v9, 8, 8
    v_bfe_u32 v22, v9, 16, 8
    v_bfe_u32 v23, v9, 24, 8
    v_readfirstlane_b32 s56, v9
    s_mul_i32 s58, s20, 88064
    s_add_u32 s59, s98, s4
    s_lshl_b32 s59, s59, 6
    s_add_u32 s58, s58, s59
    s_lshl_b32 s59, s4, 11
    s_add_u32 s59, s59, 100352
    s_waitcnt vmcnt(6)
    s_mov_b64 exec, 0xff
    buffer_load_dword v201, v41, s[44:47], 0 offen
    s_mov_b64 exec, 0x3ffff
    buffer_load_dword v201, v200, s[36:39], 0 offen sc1
    s_mov_b64 exec, -1
    s_mov_b32 m0, s59
    s_add_u32 s59, s59, 1024
    buffer_load_dwordx4 v33, s[48:51], s58 offen lds
    s_add_u32 s58, s58, 44032
    s_mov_b32 m0, s59
    s_nop 0
    buffer_load_dwordx4 v33, s[48:51], s58 offen lds
    s_cmp_ge_u32 s3, s99
    s_cbranch_scc1 L_w1a_24
    s_sub_u32 s58, s58, 43776
    s_add_u32 s59, s59, 7168
    s_mov_b32 m0, s59
    s_add_u32 s59, s59, 1024
    buffer_load_dwordx4 v33, s[48:51], s58 offen lds
    s_add_u32 s58, s58, 44032
    s_mov_b32 m0, s59
    s_nop 0
    buffer_load_dwordx4 v33, s[48:51], s58 offen lds
    s_waitcnt vmcnt(6)
    s_branch L_w1b_25
L_w1a_24:
    s_waitcnt vmcnt(4)
L_w1b_25:
L_skip_23:
    s_waitcnt lgkmcnt(0)
    s_barrier
    ds_read_b64_tr_b16 v[60:61], v204 offset:0
    ds_read_b64_tr_b16 v[62:63], v204 offset:2048
    ds_read_b64_tr_b16 v[64:65], v205 offset:0
    ds_read_b64_tr_b16 v[66:67], v205 offset:2048
    ds_read_b64_tr_b16 v[68:69], v206 offset:0
    ds_read_b64_tr_b16 v[70:71], v206 offset:2048
    ds_read_b64_tr_b16 v[72:73], v207 offset:0
    ds_read_b64_tr_b16 v[74:75], v207 offset:2048
    ds_read_b64_tr_b16 v[76:77], v204 offset:4096
    ds_read_b64_tr_b16 v[78:79], v204 offset:6144
    ds_read_b64_tr_b16 v[80:81], v205 offset:4096
    ds_read_b64_tr_b16 v[82:83], v205 offset:6144
    ds_read_b64_tr_b16 v[84:85], v206 offset:4096
    ds_read_b64_tr_b16 v[86:87], v206 offset:6144
    ds_read_b64_tr_b16 v[88:89], v207 offset:4096
    ds_read_b64_tr_b16 v[90:91], v207 offset:6144
    ds_read_b64_tr_b16 v[92:93], v204 offset:8192
    ds_read_b64_tr_b16 v[94:95], v204 offset:10240
    ds_read_b64_tr_b16 v[96:97], v205 offset:8192
    ds_read_b64_tr_b16 v[98:99], v205 offset:10240
    ds_read_b64_tr_b16 v[100:101], v206 offset:8192
    ds_read_b64_tr_b16 v[102:103], v206 offset:10240
    ds_read_b64_tr_b16 v[104:105], v207 offset:8192
    ds_read_b64_tr_b16 v[106:107], v207 offset:10240
    ds_read_b64_tr_b16 v[108:109], v204 offset:12288
    ds_read_b64_tr_b16 v[110:111], v204 offset:14336
    ds_read_b64_tr_b16 v[112:113], v205 offset:12288
    ds_read_b64_tr_b16 v[114:115], v205 offset:14336
    ds_read_b64_tr_b16 v[116:117], v206 offset:12288
    ds_read_b64_tr_b16 v[118:119], v206 offset:14336
    ds_read_b64_tr_b16 v[120:121], v207 offset:12288
    ds_read_b64_tr_b16 v[122:123], v207 offset:14336
    ds_read_b128 v[44:47], v32
    s_lshl1_add_u32 s60, s96, s35
    s_lshl_b32 s60, s60, 15
    s_add_u32 s60, s60, 1048576
    s_lshl_b32 s59, s4, 13
    s_add_u32 s60, s60, s59
    s_add_u32 s61, s60, 4096
    v_mov_b32 v179, v9
    s_getreg_b32 s58, hwreg(HW_REG_XCC_ID, 0, 4)
    v_add_u32 v29, s58, v9
    s_and_b32 s58, s6, 15
    s_lshl2_add_u32 s58, s58, s34
    s_add_u32 s58, s58, 4096
    s_lshl_b32 s59, s35, 11
    s_add_u32 s58, s58, s59
    v_lshl_add_u32 v28, v0, 6, s58
    s_cmp_eq_u32 s35, 0
    s_cbranch_scc1 L_fo0_26
    s_waitcnt vmcnt(0)
    ds_write_b32 v4, v5 offset:192
L_wf_28:
    s_sub_u32 s7, s7, 1
    s_cbranch_scc1 L_exit
    ds_read_b32 v16, v8 offset:64
    s_waitcnt lgkmcnt(0)
    v_cmp_ne_u32 vcc, 0, v16
    s_cbranch_vccz L_wf_28
    s_branch L_fo1_27
L_fo0_26:
    s_movk_i32 s33, 32
L_hw_30:
    buffer_load_dword v16, v40, s[36:39], s34 offen offset:0 sc1
    s_waitcnt vmcnt(0)
    v_cmp_ne_u32 vcc, s56, v16
    s_cbranch_vccz L_hwd_31
    s_sub_u32 s33, s33, 1
    s_cbranch_scc0 L_hw_30
L_hwd_31:
    ds_write_b32 v8, v5 offset:64
L_fo1_27:
    buffer_load_dwordx4 v[124:127], v10, s[36:39], s60 offen offset:0 sc1
    buffer_load_dwordx4 v[128:131], v10, s[36:39], s60 offen offset:1024 sc1
    buffer_load_dwordx4 v[132:135], v10, s[36:39], s60 offen offset:2048 sc1
    buffer_load_dwordx4 v[136:139], v10, s[36:39], s60 offen offset:3072 sc1
    buffer_load_dwordx4 v[140:143], v10, s[36:39], s61 offen offset:0 sc1
    buffer_load_dwordx4 v[144:147], v10, s[36:39], s61 offen offset:1024 sc1
    buffer_load_dwordx4 v[148:151], v10, s[36:39], s61 offen offset:2048 sc1
    buffer_load_dwordx4 v[152:155], v10, s[36:39], s61 offen offset:3072 sc1
    s_cmp_ge_u32 s3, s99
    s_cbranch_scc1 L_nosl_34
L_wf_35:
    s_sub_u32 s7, s7, 1
    s_cbranch_scc1 L_exit
    ds_read_b32 v16, v8 offset:192
    s_waitcnt lgkmcnt(0)
    v_cmp_ne_u32 vcc, 0, v16
    s_cbranch_vccz L_wf_35
    ds_read_b64_tr_b16 v[188:189], v31 offset:0
    ds_read_b64_tr_b16 v[190:191], v31 offset:256
    ds_read_b64_tr_b16 v[192:193], v31 offset:8
    ds_read_b64_tr_b16 v[194:195], v31 offset:264
    s_waitcnt lgkmcnt(0)
    v_mfma_f32_16x16x32_bf16 v[156:159], v[188:191], v[44:47], 0
    v_mfma_f32_16x16x32_bf16 v[160:163], v[192:195], v[44:47], 0
    s_mov_b32 vcc_lo, 0xaaaaaaaa
    s_mov_b32 vcc_hi, 0xaaaaaaaa
    s_nop 5
    v_cndmask_b32 v180, v156, v160, vcc
    v_cndmask_b32 v181, v157, v161, vcc
    v_cndmask_b32 v182, v158, v162, vcc
    v_cndmask_b32 v183, v159, v163, vcc
    v_and_or_b32 v180, v180, s57, v20
    v_and_or_b32 v181, v181, s57, v21
    v_and_or_b32 v182, v182, s57, v22
    v_and_or_b32 v183, v183, s57, v23
L_nosl_34:
L_hpc_33:
    s_waitcnt vmcnt(7)
    v_xor_b32 v16, s56, v127
    s_waitcnt vmcnt(6)
    v_bitop3_b32 v16, v131, s56, v16 bitop3:0xbe
    s_waitcnt vmcnt(5)
    v_bitop3_b32 v16, v135, s56, v16 bitop3:0xbe
    v_max3_f32 v202, v126, v130, v134
    s_waitcnt vmcnt(4)
    v_bitop3_b32 v16, v139, s56, v16 bitop3:0xbe
    s_waitcnt vmcnt(3)
    v_bitop3_b32 v16, v143, s56, v16 bitop3:0xbe
    v_max3_f32 v202, v202, v138, v142
    s_waitcnt vmcnt(2)
    v_bitop3_b32 v16, v147, s56, v16 bitop3:0xbe
    s_waitcnt vmcnt(1)
    v_bitop3_b32 v16, v151, s56, v16 bitop3:0xbe
    v_max3_f32 v202, v202, v146, v150
    s_waitcnt vmcnt(0)
    v_bitop3_b32 v16, v155, s56, v16 bitop3:0xbe
    v_max_f32 v42, v202, v154
    v_max_f32 v202, v202, v154
    v_cmp_ne_u32 vcc, 0, v16
    s_cbranch_vccnz L_hp_32
    s_mov_b64 exec, -1
    v_permlane16_swap_b32 v42, v202
    v_max_f32 v203, v202, v42
    v_max_f32 v202, v202, v42
    s_nop 1
    v_permlane32_swap_b32 v203, v202
    v_max_f32 v202, v202, v203
    v_sub_f32 v126, v202, v126
    v_sub_f32 v130, v202, v130
    v_cvt_pk_u8_f32 v126, v126, 0, 0
    v_cvt_pk_u8_f32 v130, v130, 0, 0
    v_mul_u32_u24 v126, 0x800080, v126
    v_mul_u32_u24 v130, 0x800080, v130
    v_pk_sub_u16 v44, v124, v126 clamp
    v_pk_sub_u16 v45, v125, v126 clamp
    v_pk_sub_u16 v46, v128, v130 clamp
    v_pk_sub_u16 v47, v129, v130 clamp
    s_nop 1
    v_mfma_f32_16x16x32_bf16 v[156:159], v[60:63], v[44:47], 0
    v_sub_f32 v134, v202, v134
    v_sub_f32 v138, v202, v138
    v_cvt_pk_u8_f32 v134, v134, 0, 0
    v_mfma_f32_16x16x32_bf16 v[160:163], v[64:67], v[44:47], 0
    v_cvt_pk_u8_f32 v138, v138, 0, 0
    v_mul_u32_u24 v134, 0x800080, v134
    v_mul_u32_u24 v138, 0x800080, v138
    v_mfma_f32_16x16x32_bf16 v[164:167], v[68:71], v[44:47], 0
    v_pk_sub_u16 v48, v132, v134 clamp
    v_pk_sub_u16 v49, v133, v134 clamp
    v_pk_sub_u16 v50, v136, v138 clamp
    v_mfma_f32_16x16x32_bf16 v[168:171], v[72:75], v[44:47], 0
    v_pk_sub_u16 v51, v137, v138 clamp
    v_sub_f32 v142, v202, v142
    v_sub_f32 v146, v202, v146
    v_mfma_f32_16x16x32_bf16 v[172:175], v[184:187], v[44:47], 0
    v_cvt_pk_u8_f32 v142, v142, 0, 0
    v_cvt_pk_u8_f32 v146, v146, 0, 0
    v_mul_u32_u24 v142, 0x800080, v142
    v_mfma_f32_16x16x32_bf16 v[156:159], v[76:79], v[48:51], v[156:159]
    v_mul_u32_u24 v146, 0x800080, v146
    v_pk_sub_u16 v52, v140, v142 clamp
    v_pk_sub_u16 v53, v141, v142 clamp
    v_mfma_f32_16x16x32_bf16 v[160:163], v[80:83], v[48:51], v[160:163]
    v_pk_sub_u16 v54, v144, v146 clamp
    v_pk_sub_u16 v55, v145, v146 clamp
    v_sub_f32 v150, v202, v150
    v_mfma_f32_16x16x32_bf16 v[164:167], v[84:87], v[48:51], v[164:167]
    v_sub_f32 v154, v202, v154
    v_cvt_pk_u8_f32 v150, v150, 0, 0
    v_cvt_pk_u8_f32 v154, v154, 0, 0
    v_mfma_f32_16x16x32_bf16 v[168:171], v[88:91], v[48:51], v[168:171]
    v_mul_u32_u24 v150, 0x800080, v150
    v_mul_u32_u24 v154, 0x800080, v154
    v_pk_sub_u16 v56, v148, v150 clamp
    v_mfma_f32_16x16x32_bf16 v[172:175], v[184:187], v[48:51], v[172:175]
    v_pk_sub_u16 v57, v149, v150 clamp
    v_pk_sub_u16 v58, v152, v154 clamp
    v_pk_sub_u16 v59, v153, v154 clamp
    v_mfma_f32_16x16x32_bf16 v[172:175], v[184:187], v[52:55], v[172:175]
    s_nop 0
    v_mfma_f32_16x16x32_bf16 v[172:175], v[184:187], v[56:59], v[172:175]
    v_mfma_f32_16x16x32_bf16 v[156:159], v[92:95], v[52:55], v[156:159]
    v_mfma_f32_16x16x32_bf16 v[156:159], v[108:111], v[56:59], v[156:159]
    v_mfma_f32_16x16x32_bf16 v[160:163], v[96:99], v[52:55], v[160:163]
    v_mfma_f32_16x16x32_bf16 v[160:163], v[112:115], v[56:59], v[160:163]
    s_cmp_ge_u32 s3, s99
    s_cbranch_scc1 L_nosl_37
    s_mov_b32 exec_lo, 0x30003
    s_mov_b32 exec_hi, 0x30003
    buffer_store_dwordx4 v[180:183], v30, s[36:39], s21 offen
    s_mov_b64 exec, -1
    s_xor_b32 s21, s21, 8388608
L_nosl_37:
    v_mfma_f32_16x16x32_bf16 v[164:167], v[100:103], v[52:55], v[164:167]
    v_mfma_f32_16x16x32_bf16 v[164:167], v[116:119], v[56:59], v[164:167]
    v_mov_b32 v203, v172
    ds_write_b64 v37, v[202:203]
    ds_write_b128 v208, v[156:159] offset:0
    v_mfma_f32_16x16x32_bf16 v[168:171], v[104:107], v[52:55], v[168:171]
    ds_write_b128 v209, v[160:163] offset:1024
    v_mfma_f32_16x16x32_bf16 v[168:171], v[120:123], v[56:59], v[168:171]
    s_nop 1
    ds_write_b128 v210, v[164:167] offset:2048
    s_nop 4
    ds_write_b128 v211, v[168:171] offset:3072
    ds_write_b32 v4, v5 offset:32
    ds_read_b128 v[16:19], v7 offset:32
    ds_read_b128 v[124:127], v38
    ds_read_b128 v[128:131], v38 offset:16
    ds_read_b128 v[132:135], v36 offset:0
    ds_read_b128 v[136:139], v36 offset:4096
    ds_read_b128 v[140:143], v36 offset:8192
    ds_read_b128 v[144:147], v36 offset:12288
    s_waitcnt lgkmcnt(0)
    v_min3_u32 v16, v16, v17, v18
    v_min_u32 v16, v16, v19
    v_cmp_ne_u32 vcc, 0, v16
    s_cbranch_vccnz L_wfd_39
L_wf_38:
    s_sub_u32 s7, s7, 1
    s_cbranch_scc1 L_exit
    ds_read_b128 v[16:19], v7 offset:32
    s_waitcnt lgkmcnt(0)
    v_min3_u32 v16, v16, v17, v18
    v_min_u32 v16, v16, v19
    v_cmp_ne_u32 vcc, 0, v16
    s_cbranch_vccz L_wf_38
    ds_read_b128 v[124:127], v38
    ds_read_b128 v[128:131], v38 offset:16
    ds_read_b128 v[132:135], v36 offset:0
    ds_read_b128 v[136:139], v36 offset:4096
    ds_read_b128 v[140:143], v36 offset:8192
    ds_read_b128 v[144:147], v36 offset:12288
    s_waitcnt lgkmcnt(0)
L_wfd_39:
    s_cmp_lg_u32 s3, 7
    s_cbranch_scc1 L_skip_40
    s_mov_b32 exec_hi, 0
    buffer_store_dword v29, v28, s[36:39], 0 offen
    s_mov_b32 exec_hi, -1
    ds_write_b32 v4, v5 offset:160
L_skip_40:
    v_max3_f32 v202, v124, v126, v128
    v_max_f32 v202, v202, v130
    v_sub_f32 v124, v124, v202
    v_sub_f32 v126, v126, v202
    v_sub_f32 v128, v128, v202
    v_sub_f32 v130, v130, v202
    v_exp_f32 v124, v124
    v_exp_f32 v126, v126
    v_exp_f32 v128, v128
    v_exp_f32 v130, v130
    s_mov_b32 vcc_lo, 0xf0f0f0f0
    s_mov_b32 vcc_hi, 0xf0f0f0f0
    v_pk_mul_f32 v[132:133], v[124:125], v[132:133] op_sel_hi:[0,1]
    v_pk_mul_f32 v[134:135], v[124:125], v[134:135] op_sel_hi:[0,1]
    v_mul_f32 v42, v124, v125
    v_pk_fma_f32 v[132:133], v[126:127], v[136:137], v[132:133] op_sel_hi:[0,1,1]
    v_pk_fma_f32 v[134:135], v[126:127], v[138:139], v[134:135] op_sel_hi:[0,1,1]
    v_fmac_f32 v42, v126, v127
    v_pk_fma_f32 v[132:133], v[128:129], v[140:141], v[132:133] op_sel_hi:[0,1,1]
    v_pk_fma_f32 v[134:135], v[128:129], v[142:143], v[134:135] op_sel_hi:[0,1,1]
    v_fmac_f32 v42, v128, v129
    v_pk_fma_f32 v[132:133], v[130:131], v[144:145], v[132:133] op_sel_hi:[0,1,1]
    v_pk_fma_f32 v[134:135], v[130:131], v[146:147], v[134:135] op_sel_hi:[0,1,1]
    v_fmac_f32 v42, v130, v131
    v_cvt_pk_bf16_f32 v176, v132, v133
    v_cvt_pk_bf16_f32 v177, v134, v135
    v_cndmask_b32 v178, v202, v42, vcc
    buffer_store_dwordx4 v[176:179], v39, s[36:39], 0 offen sc1
    s_cmp_lg_u32 s3, 3
    s_cbranch_scc1 L_skip_41
    s_mov_b32 exec_hi, 0
    buffer_store_dword v29, v28, s[36:39], 0 offen
    s_mov_b32 exec_hi, -1
    ds_write_b32 v4, v5 offset:160
L_skip_41:
L_wf_44:
    s_sub_u32 s7, s7, 1
    s_cbranch_scc1 L_exit
    ds_read_b32 v16, v3 offset:172
    s_waitcnt lgkmcnt(0)
    v_cmp_ne_u32 vcc, 0, v16
    s_cbranch_vccz L_wf_44
L_wf_46:
    s_sub_u32 s7, s7, 1
    s_cbranch_scc1 L_exit
    ds_read_b32 v16, v3 offset:188
    s_waitcnt lgkmcnt(0)
    v_cmp_ne_u32 vcc, 0, v16
    s_cbranch_vccz L_wf_46
    s_cmp_ge_u32 s3, s99
    s_cbranch_scc1 L_nosl_48
    s_mov_b32 exec_lo, 0x30003
    s_mov_b32 exec_hi, 0x30003
    buffer_store_dwordx4 v[180:183], v30, s[36:39], s21 offen sc1
    s_mov_b64 exec, -1
    s_xor_b32 s21, s21, 8388608
L_nosl_48:
    s_cmp_lg_u32 s3, 4
    s_cbranch_scc1 L_skip_49
    s_mov_b32 s40, s8
    s_mov_b32 s41, s9
    s_mov_b32 s42, 0x400
    s_mov_b32 s43, 0x20000
    s_mov_b32 s44, s28
    s_mov_b32 s45, s29
    s_mov_b32 s46, 0x400
    s_mov_b32 s47, 0x20000
    buffer_load_ushort v198, v35, s[40:43], 0 offen
    buffer_load_ushort v199, v35, s[44:47], 0 offen
L_skip_49:
    s_and_b32 s58, s4, 1
    s_lshl4_add_u32 s58, s58, s20
    s_lshl2_add_u32 s97, s98, s58
    s_lshl_b32 s59, s99, 2
    s_cmp_lt_u32 s58, s59
    s_cselect_b32 s59, 2, 8
    s_and_b32 s58, s3, 6
    s_cmp_lg_u32 s58, s59
    s_cbranch_scc1 L_fin_42
    s_mov_b32 s44, s26
    s_mov_b32 s45, s27
    s_mov_b32 s46, 0x158000
    s_mov_b32 s47, 0x20000
    s_mov_b32 s48, s24
    s_mov_b32 s49, s25
    s_mov_b32 s50, 0xac0
    s_mov_b32 s51, 0x20000
    s_mov_b32 s100, 0x05040100
    s_mov_b32 s101, 0x07060302
    s_and_b32 s58, s97, 3
    s_lshr_b32 s60, s97, 2
    s_lshl_b32 s60, s60, 11
    s_lshl_b32 s58, s58, 5
    s_add_u32 s60, s60, s58
    s_add_u32 s60, s60, 196608
    v_bfe_u32 v28, v0, 1, 4
    v_lshlrev_b32 v28, 7, v28
    v_and_b32 v29, 1, v0
    v_lshl_add_u32 v28, v29, 4, v28
    v_lshlrev_b32 v29, 3, v29
    buffer_load_dwordx4 v[124:127], v28, s[36:39], s60 offen sc1
    s_mov_b32 s33, 0
    s_lshl_b32 s58, s97, 4
    buffer_load_dwordx2 v[196:197], v29, s[48:51], s58 offen
    s_lshl_b32 s58, s97, 13
    s_add_u32 s59, s58, 4096
    buffer_load_dwordx4 v[92:95], v10, s[44:47], s58 offen offset:0
    buffer_load_dwordx4 v[96:99], v10, s[44:47], s58 offen offset:1024
    buffer_load_dwordx4 v[100:103], v10, s[44:47], s58 offen offset:2048
    buffer_load_dwordx4 v[104:107], v10, s[44:47], s58 offen offset:3072
    buffer_load_dwordx4 v[108:111], v10, s[44:47], s59 offen offset:0
    buffer_load_dwordx4 v[112:115], v10, s[44:47], s59 offen offset:1024
    buffer_load_dwordx4 v[116:119], v10, s[44:47], s59 offen offset:2048
    buffer_load_dwordx4 v[120:123], v10, s[44:47], s59 offen offset:3072
    s_waitcnt vmcnt(8)
L_hhc_51:
    v_xor_b32 v124, v20, v124
    v_xor_b32 v125, v21, v125
    v_xor_b32 v126, v22, v126
    v_xor_b32 v127, v23, v127
    v_or3_b32 v16, v124, v125, v126
    v_bitop3_b32 v16, v16, v127, s57 bitop3:0x54
    v_cmp_ne_u32 vcc, 0, v16
    s_cbranch_vccnz L_hh_50
    s_mov_b64 exec, -1
    v_add_f32_dpp v124, v124, v124 row_ror:2 row_mask:0xf bank_mask:0xf
    v_add_f32_dpp v125, v125, v125 row_ror:2 row_mask:0xf bank_mask:0xf
    v_add_f32_dpp v126, v126, v126 row_ror:2 row_mask:0xf bank_mask:0xf
    v_add_f32_dpp v127, v127, v127 row_ror:2 row_mask:0xf bank_mask:0xf
    v_add_f32_dpp v124, v124, v124 row_ror:4 row_mask:0xf bank_mask:0xf
    v_add_f32_dpp v125, v125, v125 row_ror:4 row_mask:0xf bank_mask:0xf
    v_add_f32_dpp v126, v126, v126 row_ror:4 row_mask:0xf bank_mask:0xf
    v_add_f32_dpp v127, v127, v127 row_ror:4 row_mask:0xf bank_mask:0xf
    v_add_f32_dpp v124, v124, v124 row_ror:8 row_mask:0xf bank_mask:0xf
    v_add_f32_dpp v125, v125, v125 row_ror:8 row_mask:0xf bank_mask:0xf
    v_add_f32_dpp v126, v126, v126 row_ror:8 row_mask:0xf bank_mask:0xf
    v_add_f32_dpp v127, v127, v127 row_ror:8 row_mask:0xf bank_mask:0xf
    v_mov_b32 v136, v124
    v_mov_b32 v137, v125
    v_mov_b32 v138, v126
    v_mov_b32 v139, v127
    v_permlane16_swap_b32 v136, v124
    v_permlane16_swap_b32 v137, v125
    v_permlane16_swap_b32 v138, v126
    v_permlane16_swap_b32 v139, v127
    v_add_f32 v124, v124, v136
    v_add_f32 v125, v125, v137
    v_add_f32 v126, v126, v138
    v_add_f32 v127, v127, v139
    v_lshlrev_b32 v132, 16, v196
    v_and_b32 v133, 0xffff0000, v196
    v_lshlrev_b32 v134, 16, v197
    v_and_b32 v135, 0xffff0000, v197
    v_cvt_pk_bf16_f32 v124, v124, v124
    v_lshlrev_b32 v124, 16, v124
    v_cvt_pk_bf16_f32 v125, v125, v125
    v_lshlrev_b32 v125, 16, v125
    v_cvt_pk_bf16_f32 v126, v126, v126
    v_lshlrev_b32 v126, 16, v126
    v_cvt_pk_bf16_f32 v127, v127, v127
    v_lshlrev_b32 v127, 16, v127
    v_add_f32 v124, v124, v132
    v_add_f32 v125, v125, v133
    v_add_f32 v126, v126, v134
    v_add_f32 v127, v127, v135
    v_cvt_pk_bf16_f32 v124, v124, v124
    v_lshlrev_b32 v124, 16, v124
    v_cvt_pk_bf16_f32 v125, v125, v125
    v_lshlrev_b32 v125, 16, v125
    v_cvt_pk_bf16_f32 v126, v126, v126
    v_lshlrev_b32 v126, 16, v126
    v_cvt_pk_bf16_f32 v127, v127, v127
    v_lshlrev_b32 v127, 16, v127
    v_mul_f32 v136, v124, v124
    v_mul_f32 v137, v125, v125
    v_mul_f32 v138, v126, v126
    v_mul_f32 v139, v127, v127
    v_mul_f32 v136, 0xbdd2d3e8, v136
    v_mul_f32 v137, 0xbdd2d3e8, v137
    v_mul_f32 v138, 0xbdd2d3e8, v138
    v_mul_f32 v139, 0xbdd2d3e8, v139
    v_add_f32 v136, 0xc0135761, v136
    v_add_f32 v137, 0xc0135761, v137
    v_add_f32 v138, 0xc0135761, v138
    v_add_f32 v139, 0xc0135761, v139
    v_mul_f32 v136, v136, v124
    v_mul_f32 v137, v137, v125
    v_mul_f32 v138, v138, v126
    v_mul_f32 v139, v139, v127
    v_exp_f32 v136, v136
    v_exp_f32 v137, v137
    v_exp_f32 v138, v138
    v_exp_f32 v139, v139
    v_add_f32 v136, 1.0, v136
    v_add_f32 v137, 1.0, v137
    v_add_f32 v138, 1.0, v138
    v_add_f32 v139, 1.0, v139
    v_rcp_f32 v136, v136
    v_rcp_f32 v137, v137
    v_rcp_f32 v138, v138
    v_rcp_f32 v139, v139
    v_mul_f32 v124, v124, v136
    v_mul_f32 v125, v125, v137
    v_mul_f32 v126, v126, v138
    v_mul_f32 v127, v127, v139
    v_cvt_pk_bf16_f32 v136, v124, v125
    v_cvt_pk_bf16_f32 v137, v126, v127
    s_nop 0
    v_mov_b32_dpp v138, v136 quad_perm:[1,0,3,2] row_mask:0xf bank_mask:0xf
    v_mov_b32_dpp v139, v137 quad_perm:[1,0,3,2] row_mask:0xf bank_mask:0xf
    s_mov_b32 vcc_lo, 0x100001
    s_mov_b32 vcc_hi, 0x10000100
    v_cndmask_b32 v136, 0, v136, vcc
    v_cndmask_b32 v137, 0, v137, vcc
    v_cndmask_b32 v138, 0, v138, vcc
    v_cndmask_b32 v139, 0, v139, vcc
    s_waitcnt vmcnt(6)
    v_perm_b32 v60, v96, v92, s100
    v_perm_b32 v64, v96, v92, s101
    v_perm_b32 v68, v97, v93, s100
    v_perm_b32 v72, v97, v93, s101
    v_perm_b32 v76, v98, v94, s100
    v_perm_b32 v80, v98, v94, s101
    v_perm_b32 v84, v99, v95, s100
    v_perm_b32 v88, v99, v95, s101
    s_waitcnt vmcnt(4)
    v_perm_b32 v61, v104, v100, s100
    v_perm_b32 v65, v104, v100, s101
    v_perm_b32 v69, v105, v101, s100
    v_perm_b32 v73, v105, v101, s101
    v_perm_b32 v77, v106, v102, s100
    v_perm_b32 v81, v106, v102, s101
    v_perm_b32 v85, v107, v103, s100
    v_perm_b32 v89, v107, v103, s101
    s_waitcnt vmcnt(2)
    v_perm_b32 v62, v112, v108, s100
    v_perm_b32 v66, v112, v108, s101
    v_perm_b32 v70, v113, v109, s100
    v_perm_b32 v74, v113, v109, s101
    v_perm_b32 v78, v114, v110, s100
    v_perm_b32 v82, v114, v110, s101
    v_perm_b32 v86, v115, v111, s100
    v_perm_b32 v90, v115, v111, s101
    s_waitcnt vmcnt(0)
    v_perm_b32 v63, v120, v116, s100
    v_perm_b32 v67, v120, v116, s101
    v_perm_b32 v71, v121, v117, s100
    v_perm_b32 v75, v121, v117, s101
    v_perm_b32 v79, v122, v118, s100
    v_perm_b32 v83, v122, v118, s101
    v_perm_b32 v87, v123, v119, s100
    v_perm_b32 v91, v123, v119, s101
    v_mfma_f32_16x16x32_bf16 v[92:95], v[136:139], v[60:63], 0
    v_mfma_f32_16x16x32_bf16 v[96:99], v[136:139], v[64:67], 0
    v_mfma_f32_16x16x32_bf16 v[100:103], v[136:139], v[68:71], 0
    v_mfma_f32_16x16x32_bf16 v[104:107], v[136:139], v[72:75], 0
    v_mfma_f32_16x16x32_bf16 v[108:111], v[136:139], v[76:79], 0
    v_mfma_f32_16x16x32_bf16 v[112:115], v[136:139], v[80:83], 0
    v_mfma_f32_16x16x32_bf16 v[116:119], v[136:139], v[84:87], 0
    v_mfma_f32_16x16x32_bf16 v[120:123], v[136:139], v[88:91], 0
    v_and_b32 v28, 56, v0
    v_add_lshl_u32 v28, v28, v0, 4
    s_lshl_b32 s58, s97, 11
    s_add_u32 s58, s58, 4194304
    v_and_or_b32 v140, v92, s57, v20
    v_and_or_b32 v141, v96, s57, v21
    v_and_or_b32 v142, v100, s57, v22
    v_and_or_b32 v143, v104, s57, v23
    v_and_or_b32 v144, v108, s57, v20
    v_and_or_b32 v145, v112, s57, v21
    v_and_or_b32 v146, v116, s57, v22
    v_and_or_b32 v147, v120, s57, v23
    buffer_store_dwordx4 v[140:143], v28, s[36:39], s58 offen offset:0 sc1
    buffer_store_dwordx4 v[144:147], v28, s[36:39], s58 offen offset:128 sc1
L_fin_42:
    s_mov_b32 s48, s30
    s_mov_b32 s49, s31
    s_mov_b32 s50, 0x400
    s_mov_b32 s51, 0x20000
    s_cmp_eq_u32 s35, 0
    s_cselect_b32 s61, 64, 43
    s_cselect_b32 s58, 0, -512
    s_mov_b32 s59, 3145728
    s_cselect_b32 s60, s59, 4194304
    s_add_u32 s34, s34, s58
    s_mul_i32 s59, s4, s61
    s_lshl_b32 s59, s59, 11
    s_add_u32 s60, s60, s59
    s_lshl4_add_u32 s58, s5, s20
    s_lshl4_add_u32 s60, s58, s60
    v_lshlrev_b32 v31, 11, v0
    v_cmp_gt_u32 vcc, s61, v0
    s_mov_b64 s[20:21], vcc
    v_lshlrev_b32 v29, 5, v2
    v_add_u32 v29, 162816, v29
    v_lshl_add_u32 v30, s3, 2, v29
    v_lshlrev_b32 v32, 2, v0
    v_add_u32 v32, 256, v32
    v_mov_b32 v124, 0
    v_mov_b32 v125, 0
    v_mov_b32 v126, 0
    v_mov_b32 v127, 0
    s_movk_i32 s33, 48
L_hw_52:
    buffer_load_dword v16, v32, s[36:39], s34 offen offset:1024 sc1
    s_waitcnt vmcnt(0)
    v_cmp_ne_u32 vcc, s56, v16
    s_cbranch_vccz L_hwd_53
    s_sub_u32 s33, s33, 1
    s_cbranch_scc0 L_hw_52
L_hwd_53:
    s_mov_b64 exec, s[20:21]
    buffer_load_dwordx4 v[124:127], v31, s[36:39], s60 offen sc1
    s_waitcnt vmcnt(0)
L_h5c_55:
    v_xor_b32 v124, v20, v124
    v_xor_b32 v125, v21, v125
    v_xor_b32 v126, v22, v126
    v_xor_b32 v127, v23, v127
    v_or3_b32 v16, v124, v125, v126
    v_bitop3_b32 v16, v16, v127, s57 bitop3:0x54
    v_cmp_ne_u32 vcc, 0, v16
    s_cbranch_vccnz L_h5_54
    s_mov_b64 exec, -1
    v_permlane32_swap_b32 v124, v125
    v_permlane32_swap_b32 v126, v127
    v_add_f32 v124, v124, v125
    v_add_f32 v126, v126, v127
    s_nop 1
    v_permlane16_swap_b32 v124, v126
    v_add_f32 v124, v124, v126
    s_nop 1
    v_add_f32_dpp v124, v124, v124 row_ror:8 row_mask:0xf bank_mask:0xf
    s_nop 1
    v_add_f32_dpp v124, v124, v124 row_ror:4 row_mask:0xf bank_mask:0xf
    s_nop 1
    v_add_f32_dpp v124, v124, v124 row_ror:2 row_mask:0xf bank_mask:0xf
    s_nop 1
    v_add_f32_dpp v124, v124, v124 row_ror:1 row_mask:0xf bank_mask:0xf
    ds_write_b32 v30, v124
    ds_write_b32 v4, v5 offset:96
    s_cmp_lg_u32 s3, 4
    s_cbranch_scc1 L_done_43
    v_lshlrev_b32 v198, 16, v198
    v_lshlrev_b32 v199, 16, v199
L_wf_56:
    s_sub_u32 s7, s7, 1
    s_cbranch_scc1 L_exit
    ds_read_b128 v[16:19], v3 offset:112
    ds_read_b128 v[128:131], v29 offset:16
    s_waitcnt lgkmcnt(0)
    v_min3_u32 v16, v16, v17, v18
    v_min_u32 v16, v16, v19
    v_cmp_ne_u32 vcc, 0, v16
    s_cbranch_vccz L_wf_56
    v_pk_add_f32 v[128:129], v[128:129], v[130:131]
    v_add_f32 v128, v128, v129
    v_cvt_pk_bf16_f32 v128, v128, v128
    v_lshlrev_b32 v128, 16, v128
    v_add_f32 v128, v128, v199
    v_cvt_pk_bf16_f32 v128, v128, v128
    v_lshlrev_b32 v128, 16, v128
    v_mul_f32 v42, 0xbfb8aa3b, v128
    v_exp_f32 v42, v42
    s_nop 0
    v_add_f32 v42, 1.0, v42
    v_rcp_f32 v42, v42
    s_nop 0
    v_mul_f32 v128, v128, v42
    v_cvt_pk_bf16_f32 v128, v128, v128
    v_lshlrev_b32 v128, 16, v128
    s_mov_b32 exec_lo, 0x10001
    s_mov_b32 exec_hi, 0x10001
L_wf_58:
    s_sub_u32 s7, s7, 1
    s_cbranch_scc1 L_exit
    ds_read_b128 v[16:19], v3 offset:96
    ds_read_b128 v[124:127], v29
    s_waitcnt lgkmcnt(0)
    v_min3_u32 v16, v16, v17, v18
    v_min_u32 v16, v16, v19
    v_cmp_ne_u32 vcc, 0, v16
    s_cbranch_vccz L_wf_58
    v_pk_add_f32 v[124:125], v[124:125], v[126:127]
    v_add_f32 v124, v124, v125
    v_cvt_pk_bf16_f32 v124, v124, v124
    v_lshlrev_b32 v124, 16, v124
    v_mul_f32 v124, v124, v128
    v_cvt_pk_bf16_f32 v124, v124, v124
    v_lshlrev_b32 v124, 16, v124
    v_add_f32 v124, v124, v198
    v_cvt_pk_bf16_f32 v124, v124, v124
    buffer_store_short v124, v35, s[48:51], 0 offen
L_done_43:
    s_endpgm
L_hp_32:
    s_mov_b64 exec, vcc
    buffer_load_dwordx4 v[124:127], v10, s[36:39], s60 offen offset:0 sc1
    buffer_load_dwordx4 v[128:131], v10, s[36:39], s60 offen offset:1024 sc1
    buffer_load_dwordx4 v[132:135], v10, s[36:39], s60 offen offset:2048 sc1
    buffer_load_dwordx4 v[136:139], v10, s[36:39], s60 offen offset:3072 sc1
    buffer_load_dwordx4 v[140:143], v10, s[36:39], s61 offen offset:0 sc1
    buffer_load_dwordx4 v[144:147], v10, s[36:39], s61 offen offset:1024 sc1
    buffer_load_dwordx4 v[148:151], v10, s[36:39], s61 offen offset:2048 sc1
    buffer_load_dwordx4 v[152:155], v10, s[36:39], s61 offen offset:3072 sc1
    s_sub_u32 s7, s7, 1
    s_cbranch_scc1 L_exit
    s_waitcnt vmcnt(0)
    s_branch L_hpc_33
L_hh_50:
    s_mov_b64 exec, vcc
    s_add_u32 s33, s33, 1
    s_cmp_lt_u32 s33, 24
    s_cselect_b32 s62, 0, 8388608
    s_xor_b32 s60, s60, s62
    buffer_load_dwordx4 v[124:127], v28, s[36:39], s60 offen sc1
    s_sub_u32 s7, s7, 1
    s_cbranch_scc1 L_exit
    s_waitcnt vmcnt(0)
    s_branch L_hhc_51
L_h5_54:
    s_mov_b64 exec, vcc
    buffer_load_dwordx4 v[124:127], v31, s[36:39], s60 offen sc1
    s_sub_u32 s7, s7, 1
    s_cbranch_scc1 L_exit
    s_waitcnt vmcnt(0)
    s_branch L_h5c_55
L_exit:
    s_endpgm
L_codeend:
.section .rodata,"a"
.p2align 6
.amdhsa_kernel recurrent_scan__compressed_kv_cla__mixer_channel_mlp__decode_kernel
  .amdhsa_next_free_vgpr 216
  .amdhsa_next_free_sgpr 102
  .amdhsa_accum_offset 216
  .amdhsa_group_segment_fixed_size 0
  .amdhsa_kernarg_size 112
  .amdhsa_user_sgpr_count 2
  .amdhsa_user_sgpr_kernarg_segment_ptr 1
  .amdhsa_system_sgpr_workgroup_id_x 1
.end_amdhsa_kernel
```
